```python
import torch

def _softmax(x, axis=-1):
    return torch.softmax(x, dim=axis)
def _gelu(x):
    return torch.nn.functional.gelu(x, approximate="tanh")
def _silu(x):
    return torch.nn.functional.silu(x)
def _sigmoid(x):
    return torch.sigmoid(x)
def _layernorm(x, axis=-1, eps=1e-5):
    m = x.mean(dim=axis, keepdim=True)
    v = x.var(dim=axis, keepdim=True, unbiased=False)
    return (x - m) / torch.sqrt(v + eps)
def _scatter_add(tgt, idx, src, axis=0):
    return tgt.clone().index_add_(axis, idx, src)
def _segment_sum(src, seg, n):
    out = torch.zeros((n,) + src.shape[1:], dtype=src.dtype)
    return out.index_add_(0, seg, src)
def _pad(x, pw):
    flat = tuple(v for pair in reversed(pw) for v in pair)
    return torch.nn.functional.pad(x, flat)

kernel_name = 'sequential_preLN__sliding_block_cached__geglu_ffn__decode'

def setup_inputs():

    _w = (lambda a: (lambda t: t.to(torch.bfloat16) if t.is_floating_point() else t)(torch.as_tensor(a)))
    def _A_setup():
        B, Sq, D = 4, 1, 512
        Hq, Hkv, Sk, Dh = 32, 8, 8192, 128
        assert Hq % Hkv == 0, (Hq, Hkv)
        return {
            "x": _w((lambda *s: torch.randn(*s, dtype=torch.bfloat16) * 0.05)(B, Sq, D)),
            "k_cache": _w((lambda *s: torch.randn(*s, dtype=torch.bfloat16) * 3.2)(B, Hkv, Sk, Dh)),
            "v_cache": _w((lambda *s: torch.randn(*s, dtype=torch.bfloat16) * 0.4)(B, Hkv, Sk, Dh)),
            "wq": _w((lambda *s: torch.randn(*s, dtype=torch.bfloat16) * 3.2)(D, Hq * Dh) * (D ** -0.5)),
            "wo": _w((lambda *s: torch.randn(*s, dtype=torch.bfloat16) * 0.4)(Hq * Dh, D) * ((Hq * Dh) ** -0.5)),
        }
    _A_in = _A_setup()

    def _B_setup():
        B, S, D, F = 4, 1, 512, 1792
        return {
            "x": _w((lambda *s: torch.randn(*s, dtype=torch.bfloat16) * 0.05)(B, S, D)),
            "w_gate": _w((lambda *s: torch.randn(*s, dtype=torch.bfloat16) * 0.05)(D, F)),
            "w_up": _w((lambda *s: torch.randn(*s, dtype=torch.bfloat16) * 0.05)(D, F)),
            "w_down": _w((lambda *s: torch.randn(*s, dtype=torch.bfloat16) * 0.05)(F, D)),
        }
    _B_in = _B_setup()

    return {
        "A_x": _A_in["x"],
        "A_k_cache": _A_in["k_cache"],
        "A_v_cache": _A_in["v_cache"],
        "A_wq": _A_in["wq"],
        "A_wo": _A_in["wo"],
        "B_x": _B_in["x"],
        "B_w_gate": _B_in["w_gate"],
        "B_w_up": _B_in["w_up"],
        "B_w_down": _B_in["w_down"],
    }

def reference(A_x, A_k_cache, A_v_cache, A_wq, A_wo, B_x, B_w_gate, B_w_up, B_w_down):
    def _A_ref(x, k_cache, v_cache, wq, wo):
        B, Sq, D = x.shape
        Hq, Dh = 32, 128
        Hkv, Sk = k_cache.shape[1], k_cache.shape[2]
        W = min(4096, max(256, Sk // 4))
        rep = Hq // Hkv
        q = (lambda x, *d: x.permute(*d))((x @ wq).reshape(B, Sq, Hq, Dh), 0, 2, 1, 3)
        k = (lambda x, n, axis: torch.repeat_interleave(x, n, dim=axis))(k_cache[:, :, Sk - W:, :], rep, axis=1)
        v = (lambda x, n, axis: torch.repeat_interleave(x, n, dim=axis))(v_cache[:, :, Sk - W:, :], rep, axis=1)
        scores = torch.einsum("bhqd,bhkd->bhqk", q, k) * (Dh ** -0.5)
        p = _softmax(scores, axis=-1)
        o = torch.einsum("bhqk,bhkd->bhqd", p, v)
        return (lambda x, *d: x.permute(*d))(o, 0, 2, 1, 3).reshape(B, Sq, Hq * Dh) @ wo

    def _B_ref(x, w_gate, w_up, w_down):
        return (_gelu(x @ w_gate) * (x @ w_up)) @ w_down

    x = A_x
    h = x + _A_ref(_layernorm(x, axis=-1), A_k_cache, A_v_cache, A_wq, A_wo)
    h2 = h + _B_ref(_layernorm(h, axis=-1), B_w_gate, B_w_up, B_w_down)
    return h2
```

```asm
; @launch grid=(256,1,1) block=(512,1,1) lds=163840
.amdgcn_target "amdgcn-amd-amdhsa--gfx950"
.text
.globl sequential_preLN__sliding_block_cached__geglu_ffn__decode_kernel
.p2align 8
.type sequential_preLN__sliding_block_cached__geglu_ffn__decode_kernel,@function
sequential_preLN__sliding_block_cached__geglu_ffn__decode_kernel:
    s_cmp_ge_u32 s2, 256
    s_cbranch_scc1 L_end
    s_load_dwordx16 s[4:19], s[0:1], 0
    s_load_dwordx8 s[20:27], s[0:1], 64
    v_and_b32 v1, 63, v0
    v_lshrrev_b32 v4, 6, v0
    s_and_b32 s28, s2, 7
    v_readfirstlane_b32 s32, v4
    s_lshr_b32 s29, s2, 3
    s_lshr_b32 s30, s29, 3
    s_and_b32 s31, s29, 7
    s_mov_b32 s35, 0x07060500
    s_mov_b32 s66, 0
    s_cmp_ge_u32 s32, 4
    s_cbranch_scc1 L_loader
    v_mov_b32 v5, 159360
    v_mov_b32 v6, 1
    s_branch L_comp
L_loader:
    s_sub_u32 s57, s32, 4
    s_lshl_b32 s52, s30, 20
    s_lshl_b32 s53, s28, 10
    s_add_u32 s52, s52, s53
    s_lshl_b32 s53, s31, 7
    s_add_u32 s52, s52, s53
    s_lshl_b32 s55, s30, 3
    s_add_u32 s55, s55, s28
    s_lshl_b32 s55, s55, 21
    s_lshl_b32 s53, s31, 16
    s_add_u32 s55, s55, s53
    s_add_u32 s55, s55, 1572864
    s_mov_b32 s38, 4096
    s_mov_b32 s39, 0x20000
    s_sub_u32 s42, 4194304, s52
    s_mov_b32 s43, 0x20000
    s_mov_b32 s46, 65536
    s_mov_b32 s47, 0x20000
    s_mov_b32 s50, 65536
    s_mov_b32 s51, 0x20000
    v_lshlrev_b32 v4, 4, v1
    v_lshrrev_b32 v20, 3, v1
    v_and_b32 v21, 7, v1
    v_bfe_u32 v22, v1, 4, 1
    v_lshlrev_b32 v22, 1, v22
    v_lshlrev_b32 v20, 13, v20
    v_xor_b32 v23, v21, v22
    v_lshl_add_u32 v6, v23, 4, v20
    v_xor_b32 v23, 4, v23
    v_lshl_add_u32 v7, v23, 4, v20
    s_bitcmp1_b32 s57, 0
    s_cselect_b64 s[60:61], -1, 0
    v_cndmask_b32 v28, v6, v7, s[60:61]
    v_lshrrev_b32 v20, 4, v1
    v_and_b32 v21, 15, v1
    v_lshlrev_b32 v22, 8, v20
    s_lshl_b32 s53, s57, 2
    v_add_u32 v23, s53, v20
    v_xor_b32 v23, v21, v23
    v_lshl_add_u32 v8, v23, 4, v22
    s_lshr_b32 s53, s57, 1
    s_lshl_b32 s53, s53, 2
    v_add_u32 v23, s53, v20
    v_lshlrev_b32 v23, 1, v23
    v_xor_b32 v23, v21, v23
    v_lshl_add_u32 v9, v23, 4, v22
    s_lshl_b32 s58, s57, 10
    s_lshl_b32 s59, s57, 2
    s_add_u32 s59, s59, 159360
    v_mov_b32 v16, s59
    s_lshl_b32 s54, s31, 1
    s_lshr_b32 s69, s28, 2
    s_waitcnt lgkmcnt(0)
    s_mov_b32 s36, s4
    s_mov_b32 s37, s5
    s_add_u32 s40, s10, s52
    s_addc_u32 s41, s11, 0
    s_add_u32 s44, s6, s55
    s_addc_u32 s45, s7, 0
    s_add_u32 s48, s8, s55
    s_addc_u32 s49, s9, 0
    s_mov_b32 s56, s58
    s_add_u32 m0, s58, 147456
    s_nop 0
    buffer_load_dwordx4 v4, s[36:39], s56 offen lds
    s_add_u32 s55, s29, 0
    s_and_b32 s55, s55, 3
    s_lshl_b32 s56, s55, 18
    s_lshl_b32 s53, s57, 16
    s_add_u32 s56, s56, s53
    s_lshl_b32 s55, s55, 12
    s_add_u32 s55, s55, s58
    s_add_u32 m0, s55, 131072
    s_nop 0
    buffer_load_dwordx4 v28, s[40:43], s56 offen nt lds
    s_add_u32 s55, s29, 1
    s_and_b32 s55, s55, 3
    s_lshl_b32 s56, s55, 18
    s_lshl_b32 s53, s57, 16
    s_add_u32 s56, s56, s53
    s_lshl_b32 s55, s55, 12
    s_add_u32 s55, s55, s58
    s_add_u32 m0, s55, 131072
    s_nop 0
    buffer_load_dwordx4 v28, s[40:43], s56 offen nt lds
    s_add_u32 s55, s29, 2
    s_and_b32 s55, s55, 3
    s_lshl_b32 s56, s55, 18
    s_lshl_b32 s53, s57, 16
    s_add_u32 s56, s56, s53
    s_lshl_b32 s55, s55, 12
    s_add_u32 s55, s55, s58
    s_add_u32 m0, s55, 131072
    s_nop 0
    buffer_load_dwordx4 v28, s[40:43], s56 offen nt lds
    s_add_u32 s55, s29, 3
    s_and_b32 s55, s55, 3
    s_lshl_b32 s56, s55, 18
    s_lshl_b32 s53, s57, 16
    s_add_u32 s56, s56, s53
    s_lshl_b32 s55, s55, 12
    s_add_u32 s55, s55, s58
    s_add_u32 m0, s55, 131072
    s_nop 0
    buffer_load_dwordx4 v28, s[40:43], s56 offen nt lds
    s_cmp_eq_u32 s57, 0
    s_cbranch_scc0 L_aux5
    v_cmp_gt_u32 vcc, 32, v1
    v_lshlrev_b32 v19, 2, v1
    v_add_u32 v19, 159232, v19
    v_cndmask_b32 v18, 0, -1, vcc
    ds_write_b32 v19, v18
    s_branch L_aux_go
L_aux5:
    s_cmp_eq_u32 s57, 3
    s_cbranch_scc1 L_aux_go
    v_mov_b32 v24, 0x3f803f80
    v_add_u32 v19, 151552, v4
    s_cmp_eq_u32 s57, 1
    s_cbranch_scc1 L_aux_w
    v_mov_b32 v24, 0
    v_add_u32 v19, 157888, v4
L_aux_w:
    v_mov_b32 v25, v24
    v_mov_b32 v26, v24
    v_mov_b32 v27, v24
    ds_write_b128 v19, v[24:27]
L_aux_go:
    s_waitcnt lgkmcnt(0)
    s_barrier
    s_add_u32 s55, s54, 0
    s_and_b32 s55, s55, 15
    s_lshl_b32 s55, s55, 12
    s_add_u32 s56, s55, s58
    s_add_u32 m0, s56, 0
    s_waitcnt vmcnt(4)
    v_mov_b32 v17, 1
    ds_write_b32 v16, v17
    buffer_load_dwordx4 v8, s[44:47], s56 offen nt lds
    s_add_u32 s55, s54, 1
    s_and_b32 s55, s55, 15
    s_lshl_b32 s55, s55, 12
    s_add_u32 s56, s55, s58
    s_add_u32 m0, s56, 0
    s_waitcnt vmcnt(4)
    buffer_load_dwordx4 v8, s[44:47], s56 offen nt lds
    s_add_u32 s55, s54, 2
    s_and_b32 s55, s55, 15
    s_lshl_b32 s55, s55, 12
    s_add_u32 s56, s55, s58
    s_add_u32 m0, s56, 0
    s_waitcnt vmcnt(4)
    buffer_load_dwordx4 v8, s[44:47], s56 offen nt lds
    s_add_u32 s55, s54, 3
    s_and_b32 s55, s55, 15
    s_lshl_b32 s55, s55, 12
    s_add_u32 s56, s55, s58
    s_add_u32 m0, s56, 0
    s_waitcnt vmcnt(4)
    buffer_load_dwordx4 v8, s[44:47], s56 offen nt lds
    s_add_u32 s55, s54, 4
    s_and_b32 s55, s55, 15
    s_lshl_b32 s55, s55, 12
    s_add_u32 s56, s55, s58
    s_add_u32 m0, s56, 0
    s_waitcnt vmcnt(4)
    v_mov_b32 v17, 2
    ds_write_b32 v16, v17
    buffer_load_dwordx4 v8, s[44:47], s56 offen nt lds
    s_add_u32 s55, s54, 5
    s_and_b32 s55, s55, 15
    s_lshl_b32 s55, s55, 12
    s_add_u32 s56, s55, s58
    s_add_u32 m0, s56, 0
    s_waitcnt vmcnt(4)
    buffer_load_dwordx4 v8, s[44:47], s56 offen nt lds
    s_add_u32 s55, s54, 6
    s_and_b32 s55, s55, 15
    s_lshl_b32 s55, s55, 12
    s_add_u32 s56, s55, s58
    s_add_u32 m0, s56, 0
    s_waitcnt vmcnt(4)
    buffer_load_dwordx4 v8, s[44:47], s56 offen nt lds
    s_add_u32 s55, s54, 7
    s_and_b32 s55, s55, 15
    s_lshl_b32 s55, s55, 12
    s_add_u32 s56, s55, s58
    s_add_u32 m0, s56, 0
    s_waitcnt vmcnt(4)
    buffer_load_dwordx4 v8, s[44:47], s56 offen nt lds
    s_add_u32 s55, s54, 8
    s_and_b32 s55, s55, 15
    s_lshl_b32 s55, s55, 12
    s_add_u32 s56, s55, s58
    s_add_u32 m0, s56, 0
    s_waitcnt vmcnt(4)
    buffer_load_dwordx4 v8, s[44:47], s56 offen nt lds
    s_add_u32 s55, s54, 9
    s_and_b32 s55, s55, 15
    s_lshl_b32 s55, s55, 12
    s_add_u32 s56, s55, s58
    s_add_u32 m0, s56, 0
    s_waitcnt vmcnt(4)
    buffer_load_dwordx4 v8, s[44:47], s56 offen nt lds
    s_add_u32 s55, s54, 10
    s_and_b32 s55, s55, 15
    s_lshl_b32 s55, s55, 12
    s_add_u32 s56, s55, s58
    s_add_u32 m0, s56, 0
    s_waitcnt vmcnt(4)
    buffer_load_dwordx4 v8, s[44:47], s56 offen nt lds
    s_add_u32 s55, s54, 11
    s_and_b32 s55, s55, 15
    s_lshl_b32 s55, s55, 12
    s_add_u32 s56, s55, s58
    s_add_u32 m0, s56, 0
    s_waitcnt vmcnt(4)
    buffer_load_dwordx4 v8, s[44:47], s56 offen nt lds
    s_add_u32 s55, s54, 12
    s_and_b32 s55, s55, 15
    s_lshl_b32 s55, s55, 12
    s_add_u32 s56, s55, s58
    s_add_u32 m0, s56, 0
    s_waitcnt vmcnt(4)
    buffer_load_dwordx4 v8, s[44:47], s56 offen nt lds
    s_add_u32 s55, s54, 13
    s_and_b32 s55, s55, 15
    s_lshl_b32 s55, s55, 12
    s_add_u32 s56, s55, s58
    s_add_u32 m0, s56, 0
    s_waitcnt vmcnt(4)
    buffer_load_dwordx4 v8, s[44:47], s56 offen nt lds
    s_add_u32 s55, s54, 14
    s_and_b32 s55, s55, 15
    s_lshl_b32 s55, s55, 12
    s_add_u32 s56, s55, s58
    s_add_u32 m0, s56, 0
    s_waitcnt vmcnt(4)
    buffer_load_dwordx4 v8, s[44:47], s56 offen nt lds
    s_add_u32 s55, s54, 15
    s_and_b32 s55, s55, 15
    s_lshl_b32 s55, s55, 12
    s_add_u32 s56, s55, s58
    s_add_u32 m0, s56, 0
    s_waitcnt vmcnt(4)
    buffer_load_dwordx4 v8, s[44:47], s56 offen nt lds
    s_add_u32 s55, s54, 0
    s_and_b32 s55, s55, 15
    s_lshl_b32 s55, s55, 12
    s_add_u32 s56, s55, s58
    s_add_u32 m0, s56, 65536
    s_waitcnt vmcnt(4)
    buffer_load_dwordx4 v9, s[48:51], s56 offen nt lds
    s_add_u32 s55, s54, 1
    s_and_b32 s55, s55, 15
    s_lshl_b32 s55, s55, 12
    s_add_u32 s56, s55, s58
    s_add_u32 m0, s56, 65536
    s_waitcnt vmcnt(4)
    buffer_load_dwordx4 v9, s[48:51], s56 offen nt lds
    s_add_u32 s55, s54, 2
    s_and_b32 s55, s55, 15
    s_lshl_b32 s55, s55, 12
    s_add_u32 s56, s55, s58
    s_add_u32 m0, s56, 65536
    s_waitcnt vmcnt(4)
    buffer_load_dwordx4 v9, s[48:51], s56 offen nt lds
    s_add_u32 s55, s54, 3
    s_and_b32 s55, s55, 15
    s_lshl_b32 s55, s55, 12
    s_add_u32 s56, s55, s58
    s_add_u32 m0, s56, 65536
    s_waitcnt vmcnt(4)
    buffer_load_dwordx4 v9, s[48:51], s56 offen nt lds
    s_add_u32 s55, s54, 4
    s_and_b32 s55, s55, 15
    s_lshl_b32 s55, s55, 12
    s_add_u32 s56, s55, s58
    s_add_u32 m0, s56, 65536
    s_waitcnt vmcnt(4)
    v_mov_b32 v17, 3
    ds_write_b32 v16, v17
    buffer_load_dwordx4 v9, s[48:51], s56 offen nt lds
    s_add_u32 s55, s54, 5
    s_and_b32 s55, s55, 15
    s_lshl_b32 s55, s55, 12
    s_add_u32 s56, s55, s58
    s_add_u32 m0, s56, 65536
    s_waitcnt vmcnt(4)
    buffer_load_dwordx4 v9, s[48:51], s56 offen nt lds
    s_add_u32 s55, s54, 6
    s_and_b32 s55, s55, 15
    s_lshl_b32 s55, s55, 12
    s_add_u32 s56, s55, s58
    s_add_u32 m0, s56, 65536
    s_waitcnt vmcnt(4)
    buffer_load_dwordx4 v9, s[48:51], s56 offen nt lds
    s_add_u32 s55, s54, 7
    s_and_b32 s55, s55, 15
    s_lshl_b32 s55, s55, 12
    s_add_u32 s56, s55, s58
    s_add_u32 m0, s56, 65536
    s_waitcnt vmcnt(4)
    buffer_load_dwordx4 v9, s[48:51], s56 offen nt lds
    s_add_u32 s55, s54, 8
    s_and_b32 s55, s55, 15
    s_lshl_b32 s55, s55, 12
    s_add_u32 s56, s55, s58
    s_add_u32 m0, s56, 65536
    s_waitcnt vmcnt(4)
    buffer_load_dwordx4 v9, s[48:51], s56 offen nt lds
    s_add_u32 s55, s54, 9
    s_and_b32 s55, s55, 15
    s_lshl_b32 s55, s55, 12
    s_add_u32 s56, s55, s58
    s_add_u32 m0, s56, 65536
    s_waitcnt vmcnt(4)
    buffer_load_dwordx4 v9, s[48:51], s56 offen nt lds
    s_add_u32 s55, s54, 10
    s_and_b32 s55, s55, 15
    s_lshl_b32 s55, s55, 12
    s_add_u32 s56, s55, s58
    s_add_u32 m0, s56, 65536
    s_waitcnt vmcnt(4)
    buffer_load_dwordx4 v9, s[48:51], s56 offen nt lds
    s_add_u32 s55, s54, 11
    s_and_b32 s55, s55, 15
    s_lshl_b32 s55, s55, 12
    s_add_u32 s56, s55, s58
    s_add_u32 m0, s56, 65536
    s_waitcnt vmcnt(4)
    buffer_load_dwordx4 v9, s[48:51], s56 offen nt lds
    s_add_u32 s55, s54, 12
    s_and_b32 s55, s55, 15
    s_lshl_b32 s55, s55, 12
    s_add_u32 s56, s55, s58
    s_add_u32 m0, s56, 65536
    s_waitcnt vmcnt(4)
    v_mov_b32 v17, 4
    ds_write_b32 v16, v17
    buffer_load_dwordx4 v9, s[48:51], s56 offen nt lds
    s_add_u32 s55, s54, 13
    s_and_b32 s55, s55, 15
    s_lshl_b32 s55, s55, 12
    s_add_u32 s56, s55, s58
    s_add_u32 m0, s56, 65536
    s_waitcnt vmcnt(4)
    buffer_load_dwordx4 v9, s[48:51], s56 offen nt lds
    s_add_u32 s55, s54, 14
    s_and_b32 s55, s55, 15
    s_lshl_b32 s55, s55, 12
    s_add_u32 s56, s55, s58
    s_add_u32 m0, s56, 65536
    s_waitcnt vmcnt(4)
    buffer_load_dwordx4 v9, s[48:51], s56 offen nt lds
    s_add_u32 s55, s54, 15
    s_and_b32 s55, s55, 15
    s_lshl_b32 s55, s55, 12
    s_add_u32 s56, s55, s58
    s_add_u32 m0, s56, 65536
    s_waitcnt vmcnt(4)
    buffer_load_dwordx4 v9, s[48:51], s56 offen nt lds
    s_waitcnt vmcnt(4)
    v_mov_b32 v17, 5
    ds_write_b32 v16, v17
    s_waitcnt vmcnt(2)
    v_mov_b32 v17, 6
    ds_write_b32 v16, v17
    s_waitcnt vmcnt(0)
    s_barrier
    s_waitcnt lgkmcnt(0)
    s_load_dword s34, s[26:27], 0
    v_mov_b32 v50, 0
    v_mov_b32 v51, 155776
    s_barrier
    s_branch L_tail_entry
L_comp:
    v_and_b32 v7, 15, v1
    v_lshrrev_b32 v8, 4, v1
    v_cmp_eq_u32 s[60:61], 1, v7
    v_cmp_eq_u32 s[62:63], 2, v7
    v_cmp_eq_u32 s[64:65], 3, v7
    v_cmp_gt_u32 s[70:71], 4, v7
    v_min_u32 v9, 4, v7
    v_lshlrev_b32 v9, 10, v9
    v_lshl_add_u32 v9, v8, 4, v9
    v_add_u32 v9, 147456, v9
    s_waitcnt lgkmcnt(0)
    s_load_dword s34, s[26:27], 0
    s_barrier
    v_bfe_u32 v11, v1, 2, 2
    v_and_b32 v12, 3, v1
    v_lshl_add_u32 v13, v8, 3, v11
    v_lshlrev_b32 v13, 7, v13
    v_lshrrev_b32 v14, 1, v11
    v_and_b32 v15, 1, v8
    v_lshl_add_u32 v14, v15, 1, v14
    v_lshlrev_b32 v14, 1, v14
    v_lshrrev_b32 v15, 1, v12
    s_lshl_b32 s36, s32, 1
    v_add_u32 v15, s36, v15
    v_xor_b32 v15, v15, v14
    v_lshl_add_u32 v13, v15, 4, v13
    v_and_b32 v12, 1, v12
    v_lshl_add_u32 v10, v12, 3, v13
    v_add_u32 v10, 131072, v10
L_wp_1:
    ds_read_b128 v[88:91], v5
    s_waitcnt lgkmcnt(0)
    v_min3_u32 v88, v88, v89, v90
    v_min_u32 v88, v88, v91
    s_nop 0
    v_readfirstlane_b32 s67, v88
    s_nop 0
    s_cmp_ge_u32 s67, 1
    s_cbranch_scc0 L_wp_1
    ds_read_b128 v[16:19], v9 offset:0
    ds_read_b128 v[20:23], v9 offset:64
    ds_read_b128 v[24:27], v9 offset:128
    ds_read_b128 v[28:31], v9 offset:192
    ds_read_b128 v[32:35], v9 offset:256
    ds_read_b128 v[36:39], v9 offset:320
    ds_read_b128 v[40:43], v9 offset:384
    ds_read_b128 v[44:47], v9 offset:448
    ds_read_b128 v[48:51], v9 offset:512
    ds_read_b128 v[52:55], v9 offset:576
    ds_read_b128 v[56:59], v9 offset:640
    ds_read_b128 v[60:63], v9 offset:704
    ds_read_b128 v[64:67], v9 offset:768
    ds_read_b128 v[68:71], v9 offset:832
    ds_read_b128 v[72:75], v9 offset:896
    ds_read_b128 v[76:79], v9 offset:960
    v_mov_b32 v80, 0
    v_mov_b32 v81, 0
    v_mov_b32 v82, 0
    v_mov_b32 v83, 0
    s_waitcnt lgkmcnt(0)
    s_nop 0
    v_mfma_f32_16x16x32_bf16 v[80:83], v[16:19], v[16:19], v[80:83]
    v_mfma_f32_16x16x32_bf16 v[80:83], v[20:23], v[20:23], v[80:83]
    v_mfma_f32_16x16x32_bf16 v[80:83], v[24:27], v[24:27], v[80:83]
    v_mfma_f32_16x16x32_bf16 v[80:83], v[28:31], v[28:31], v[80:83]
    v_mfma_f32_16x16x32_bf16 v[80:83], v[32:35], v[32:35], v[80:83]
    v_mfma_f32_16x16x32_bf16 v[80:83], v[36:39], v[36:39], v[80:83]
    v_mfma_f32_16x16x32_bf16 v[80:83], v[40:43], v[40:43], v[80:83]
    v_mfma_f32_16x16x32_bf16 v[80:83], v[44:47], v[44:47], v[80:83]
    v_mfma_f32_16x16x32_bf16 v[80:83], v[48:51], v[48:51], v[80:83]
    v_mfma_f32_16x16x32_bf16 v[80:83], v[52:55], v[52:55], v[80:83]
    v_mfma_f32_16x16x32_bf16 v[80:83], v[56:59], v[56:59], v[80:83]
    v_mfma_f32_16x16x32_bf16 v[80:83], v[60:63], v[60:63], v[80:83]
    v_mfma_f32_16x16x32_bf16 v[80:83], v[64:67], v[64:67], v[80:83]
    v_mfma_f32_16x16x32_bf16 v[80:83], v[68:71], v[68:71], v[80:83]
    v_mfma_f32_16x16x32_bf16 v[80:83], v[72:75], v[72:75], v[80:83]
    v_mfma_f32_16x16x32_bf16 v[80:83], v[76:79], v[76:79], v[80:83]
    s_lshl_b32 s36, s30, 8
    v_add_u32 v11, s36, v9
    ds_read_b128 v[16:19], v11 offset:0
    ds_read_b128 v[20:23], v11 offset:64
    ds_read_b128 v[24:27], v11 offset:128
    ds_read_b128 v[28:31], v11 offset:192
    s_nop 1
    v_cndmask_b32 v12, v80, v81, s[60:61]
    v_cndmask_b32 v12, v12, v82, s[62:63]
    v_cndmask_b32 v12, v12, v83, s[64:65]
    v_and_b32 v13, 3, v1
    v_lshlrev_b32 v13, 2, v13
    v_add_u32 v14, 64, v13
    ds_bpermute_b32 v12, v13, v12
    ds_bpermute_b32 v15, v14, v80
    s_waitcnt lgkmcnt(0)
    v_mul_f32 v84, 0.001953125, v15
    v_mul_f32 v12, 0.001953125, v12
    v_fma_f32 v12, -v84, v84, v12
    v_add_f32 v12, 0x3727c5ac, v12
    v_rsq_f32 v12, v12
    s_nop 0
    v_mul_f32 v85, 0x3e0293ee, v12
L_wp_2:
    ds_read_b128 v[88:91], v5
    s_waitcnt lgkmcnt(0)
    v_min3_u32 v88, v88, v89, v90
    v_min_u32 v88, v88, v91
    s_nop 0
    v_readfirstlane_b32 s67, v88
    s_nop 0
    s_cmp_ge_u32 s67, 2
    s_cbranch_scc0 L_wp_2
    ds_read_b64_tr_b16 v[32:33], v10 offset:0
    ds_read_b64_tr_b16 v[34:35], v10 offset:512
    ds_read_b64_tr_b16 v[36:37], v10 offset:4096
    ds_read_b64_tr_b16 v[38:39], v10 offset:4608
    ds_read_b64_tr_b16 v[40:41], v10 offset:8192
    ds_read_b64_tr_b16 v[42:43], v10 offset:8704
    ds_read_b64_tr_b16 v[44:45], v10 offset:12288
    ds_read_b64_tr_b16 v[46:47], v10 offset:12800
    v_mov_b32 v64, 0
    v_mov_b32 v65, 0
    v_mov_b32 v66, 0
    v_mov_b32 v67, 0
    s_waitcnt lgkmcnt(0)
    s_nop 0
    v_mfma_f32_16x16x32_bf16 v[64:67], v[32:35], v[16:19], v[64:67]
    v_mfma_f32_16x16x32_bf16 v[64:67], v[36:39], v[20:23], v[64:67]
    v_mfma_f32_16x16x32_bf16 v[64:67], v[40:43], v[24:27], v[64:67]
    v_mfma_f32_16x16x32_bf16 v[64:67], v[44:47], v[28:31], v[64:67]
    s_add_u32 s34, s34, 1
    s_and_b32 s33, s34, 0xff
    s_xor_b32 s37, s33, 0x80
    v_mov_b32 v2, s37
    s_getreg_b32 s38, hwreg(HW_REG_XCC_ID, 0, 4)
    s_lshl_b32 s38, s38, 8
    s_or_b32 s38, s38, s37
    v_mul_u32_u24 v11, 272, v7
    v_lshl_add_u32 v11, v8, 4, v11
    s_lshl_b32 s36, s32, 6
    s_add_u32 s36, s36, 153664
    v_add_u32 v11, s36, v11
    v_mov_b32_dpp v68, v64 row_newbcast:4 row_mask:0xf bank_mask:0xf
    v_mov_b32_dpp v69, v65 row_newbcast:4 row_mask:0xf bank_mask:0xf
    v_mov_b32_dpp v70, v66 row_newbcast:4 row_mask:0xf bank_mask:0xf
    v_mov_b32_dpp v71, v67 row_newbcast:4 row_mask:0xf bank_mask:0xf
    v_fma_f32 v64, -v84, v68, v64
    v_fma_f32 v65, -v84, v69, v65
    v_fma_f32 v66, -v84, v70, v66
    v_fma_f32 v67, -v84, v71, v67
    v_mul_f32 v64, v85, v64
    v_mul_f32 v65, v85, v65
    v_mul_f32 v66, v85, v66
    v_mul_f32 v67, v85, v67
    v_perm_b32 v64, v64, v2, s35
    v_perm_b32 v65, v65, v2, s35
    v_perm_b32 v66, v66, v2, s35
    v_perm_b32 v67, v67, v2, s35
    v_cmp_gt_u32 vcc, 4, v7
    s_nop 0
    s_and_saveexec_b64 s[36:37], vcc
    ds_write_b128 v11, v[64:67]
    s_mov_b64 exec, s[36:37]
    s_lshl_b32 s36, s32, 2
    s_add_u32 s36, s36, 159392
    v_mov_b32 v12, s36
    ds_write_b32 v12, v6
    s_cmp_eq_u32 s32, 0
    s_cbranch_scc0 L_noqpub
L_fw_3:
    ds_read_b128 v[88:91], v5 offset:32
    s_waitcnt lgkmcnt(0)
    v_min3_u32 v88, v88, v89, v90
    v_min_u32 v88, v88, v91
    s_nop 0
    v_readfirstlane_b32 s67, v88
    s_nop 0
    s_cmp_ge_u32 s67, 1
    s_cbranch_scc0 L_fw_3
    v_mul_u32_u24 v11, 272, v8
    v_lshl_add_u32 v11, v7, 4, v11
    v_add_u32 v11, 153664, v11
    ds_read_b128 v[64:67], v11
    s_lshl_b32 s36, s28, 15
    s_lshl_b32 s37, s30, 11
    s_add_u32 s36, s36, s37
    s_lshl_b32 s37, s31, 8
    s_add_u32 s36, s36, s37
    s_add_u32 s36, s36, 65536
    v_lshlrev_b32 v11, 13, v8
    v_lshl_add_u32 v11, v7, 4, v11
    v_add_u32 v11, s36, v11
    s_waitcnt lgkmcnt(0)
    global_store_dwordx4 v11, v[64:67], s[26:27] sc1
    s_lshl_b32 s36, s28, 9
    s_lshl_b32 s37, s29, 4
    s_add_u32 s36, s36, s37
    s_add_u32 s36, s36, 327680
    v_mov_b32 v11, s36
    v_mov_b32 v68, s38
    v_mov_b32 v69, s38
    v_mov_b32 v70, s38
    v_mov_b32 v71, s38
    s_mov_b64 exec, 1
    global_store_dwordx4 v11, v[68:71], s[26:27] sc1
    s_mov_b64 exec, -1
L_noqpub:
    s_cmp_eq_u32 s32, 0
    s_cbranch_scc0 L_notouch
    s_lshl_b32 s36, s28, 2
    s_add_u32 s36, s36, s30
    s_lshl_b32 s36, s36, 14
    s_lshl_b32 s37, s31, 11
    s_add_u32 s36, s36, s37
    s_add_u32 s36, s36, 524288
    v_lshlrev_b32 v12, 6, v1
    v_add_u32 v13, s36, v12
    s_lshl_b32 s36, s28, 11
    s_lshl_b32 s37, s30, 9
    s_add_u32 s36, s36, s37
    s_add_u32 s36, s36, 335872 - 2048
    v_add_u32 v14, s36, v12
    v_cmp_gt_u32 vcc, 32, v1
    s_nop 1
    v_cndmask_b32 v13, v14, v13, vcc
    v_cmp_gt_u32 vcc, 40, v1
    s_nop 0
    s_and_saveexec_b64 s[36:37], vcc
    global_load_dword v160, v13, s[26:27] sc1
    s_mov_b64 exec, s[36:37]
L_notouch:
    s_lshl_b32 s36, s28, 15
    s_lshl_b32 s37, s30, 13
    s_add_u32 s36, s36, s37
    s_lshl_b32 s37, s32, 9
    s_add_u32 s36, s36, s37
    s_add_u32 s36, s36, 65536
    v_lshrrev_b32 v86, 5, v1
    v_and_b32 v87, 31, v1
    v_lshlrev_b32 v86, 12, v86
    v_lshl_add_u32 v86, v87, 4, v86
    v_add_u32 v86, s36, v86
    s_mul_i32 s36, s32, 272
    s_add_u32 s36, s36, 152576
    v_lshlrev_b32 v87, 3, v87
    v_add_u32 v87, s36, v87
    v_lshrrev_b32 v13, 5, v1
    v_lshl_add_u32 v87, v13, 2, v87
    s_lshl_b32 s36, s32, 14
    v_lshlrev_b32 v13, 8, v7
    v_add_u32 v13, s36, v13
    v_add_u32 v14, 0, v8
    v_xor_b32 v14, v14, v7
    v_lshl_add_u32 v32, v14, 4, v13
    v_add_u32 v14, 4, v8
    v_xor_b32 v14, v14, v7
    v_lshl_add_u32 v33, v14, 4, v13
    v_add_u32 v14, 8, v8
    v_xor_b32 v14, v14, v7
    v_lshl_add_u32 v34, v14, 4, v13
    v_add_u32 v14, 12, v8
    v_xor_b32 v14, v14, v7
    v_lshl_add_u32 v35, v14, 4, v13
    v_and_b32 v13, 3, v7
    v_lshlrev_b32 v58, 4, v13
    v_add_u32 v58, 159232, v58
    s_lshl_b32 s36, s32, 2
    v_add_u32 v59, s36, v58
    v_mul_u32_u24 v14, 528, v13
    v_lshl_add_u32 v37, v8, 4, v14
    v_add_u32 v37, 153664, v37
    v_lshrrev_b32 v15, 2, v7
    v_lshlrev_b32 v15, 5, v15
    v_lshl_add_u32 v15, v8, 3, v15
    s_lshl_b32 s36, s32, 7
    s_add_u32 s36, s36, 153664
    v_add3_u32 v36, v14, v15, s36
    v_mul_u32_u24 v38, 272, v13
    v_lshl_add_u32 v38, v8, 4, v38
    v_add_u32 v38, 152576, v38
    s_lshl_b32 s36, s32, 2
    s_add_u32 s36, s36, 159376
    v_mov_b32 v39, s36
    v_bfe_u32 v11, v1, 2, 2
    v_and_b32 v12, 3, v1
    v_lshl_add_u32 v13, v8, 3, v11
    v_lshlrev_b32 v13, 8, v13
    v_and_b32 v14, 1, v8
    v_lshl_add_u32 v14, v14, 2, v11
    v_lshlrev_b32 v14, 1, v14
    v_lshrrev_b32 v15, 1, v12
    s_lshl_b32 s36, s32, 2
    v_add_u32 v15, s36, v15
    v_and_b32 v12, 1, v12
    v_lshl_add_u32 v13, v12, 3, v13
    v_add_u32 v13, 65536, v13
    v_xor_b32 v12, v15, v14
    v_lshl_add_u32 v72, v12, 4, v13
    v_add_u32 v15, 2, v15
    v_xor_b32 v12, v15, v14
    v_lshl_add_u32 v73, v12, 4, v13
    v_mov_b32 v76, 0
    v_mov_b32 v77, 0
    v_mov_b32 v78, 0
    v_mov_b32 v79, 0
    v_mov_b32 v80, 0
    v_mov_b32 v81, 0
    v_mov_b32 v82, 0
    v_mov_b32 v83, 0
    s_lshl_b32 s36, s28, 16
    s_lshl_b32 s37, s29, 9
    s_add_u32 s36, s36, s37
    s_lshl_b32 s37, s32, 7
    s_add_u32 s36, s36, s37
    s_add_u32 s36, s36, 524288
    v_lshlrev_b32 v74, 14, v7
    v_lshl_add_u32 v74, v8, 4, v74
    v_add_u32 v74, s36, v74
    s_lshl_b32 s37, s32, 10
    s_add_u32 s37, s37, 32768
    v_mul_u32_u24 v66, 144, v7
    v_lshl_add_u32 v66, v8, 4, v66
    v_add_u32 v66, s37, v66
    v_bfe_u32 v67, v1, 3, 2
    v_and_b32 v75, 7, v1
    v_mul_u32_u24 v68, 144, v67
    v_lshl_add_u32 v68, v75, 4, v68
    v_lshlrev_b32 v69, 14, v67
    v_lshl_add_u32 v75, v75, 4, v69
    v_add_u32 v75, s36, v75
    v_add_u32 v67, s37, v68
    s_add_u32 s36, s31, 0
    s_and_b32 s36, s36, 7
    s_lshl_b32 s36, s36, 13
    v_add_u32 v164, s36, v72
    v_add_u32 v165, s36, v73
    s_add_u32 s36, s31, 1
    s_and_b32 s36, s36, 7
    s_lshl_b32 s36, s36, 13
    v_add_u32 v166, s36, v72
    v_add_u32 v167, s36, v73
    s_add_u32 s36, s31, 2
    s_and_b32 s36, s36, 7
    s_lshl_b32 s36, s36, 13
    v_add_u32 v168, s36, v72
    v_add_u32 v169, s36, v73
    s_add_u32 s36, s31, 3
    s_and_b32 s36, s36, 7
    s_lshl_b32 s36, s36, 13
    v_add_u32 v170, s36, v72
    v_add_u32 v171, s36, v73
    s_add_u32 s36, s31, 4
    s_and_b32 s36, s36, 7
    s_lshl_b32 s36, s36, 13
    v_add_u32 v172, s36, v72
    v_add_u32 v173, s36, v73
    s_add_u32 s36, s31, 5
    s_and_b32 s36, s36, 7
    s_lshl_b32 s36, s36, 13
    v_add_u32 v174, s36, v72
    v_add_u32 v175, s36, v73
    s_add_u32 s36, s31, 6
    s_and_b32 s36, s36, 7
    s_lshl_b32 s36, s36, 13
    v_add_u32 v176, s36, v72
    v_add_u32 v177, s36, v73
    s_add_u32 s36, s31, 7
    s_and_b32 s36, s36, 7
    s_lshl_b32 s36, s36, 13
    v_add_u32 v178, s36, v72
    v_add_u32 v179, s36, v73
    s_add_u32 s36, s31, 0
    s_and_b32 s36, s36, 7
    s_lshl_b32 s36, s36, 6
    v_add_u32 v244, s36, v37
    s_add_u32 s36, s31, 1
    s_and_b32 s36, s36, 7
    s_lshl_b32 s36, s36, 6
    v_add_u32 v245, s36, v37
    s_add_u32 s36, s31, 2
    s_and_b32 s36, s36, 7
    s_lshl_b32 s36, s36, 6
    v_add_u32 v246, s36, v37
    s_add_u32 s36, s31, 3
    s_and_b32 s36, s36, 7
    s_lshl_b32 s36, s36, 6
    v_add_u32 v247, s36, v37
    s_add_u32 s36, s31, 4
    s_and_b32 s36, s36, 7
    s_lshl_b32 s36, s36, 6
    v_add_u32 v248, s36, v37
    s_add_u32 s36, s31, 5
    s_and_b32 s36, s36, 7
    s_lshl_b32 s36, s36, 6
    v_add_u32 v249, s36, v37
    s_add_u32 s36, s31, 6
    s_and_b32 s36, s36, 7
    s_lshl_b32 s36, s36, 6
    v_add_u32 v250, s36, v37
    s_add_u32 s36, s31, 7
    s_and_b32 s36, s36, 7
    s_lshl_b32 s36, s36, 6
    v_add_u32 v251, s36, v37
    v_mov_b32 v40, 0
    v_mov_b32 v41, 0
    v_mov_b32 v42, 0
    v_mov_b32 v43, 0
    v_mov_b32 v44, 0
    v_mov_b32 v45, 0
    v_mov_b32 v46, 0
    v_mov_b32 v47, 0
    v_mov_b32 v48, 0
    v_mov_b32 v49, 0
    v_mov_b32 v50, 0
    v_mov_b32 v51, 0
    v_mov_b32 v52, 0
    v_mov_b32 v53, 0
    v_mov_b32 v54, 0
    v_mov_b32 v55, 0
    s_sleep 22
    global_load_dwordx4 v[16:19], v86, s[26:27] sc1
    global_load_dwordx4 v[20:23], v86, s[26:27] offset:2048 sc1
L_wp_5:
    ds_read_b128 v[88:91], v5
    s_waitcnt lgkmcnt(0)
    v_min3_u32 v88, v88, v89, v90
    v_min_u32 v88, v88, v91
    s_nop 0
    v_readfirstlane_b32 s67, v88
    s_nop 0
    s_cmp_ge_u32 s67, 3
    s_cbranch_scc0 L_wp_5
    ds_read_b128 v[96:99], v32 offset:0
    ds_read_b128 v[100:103], v33 offset:0
    ds_read_b128 v[104:107], v34 offset:0
    ds_read_b128 v[108:111], v35 offset:0
    ds_read_b128 v[112:115], v32 offset:4096
    ds_read_b128 v[116:119], v33 offset:4096
    ds_read_b128 v[120:123], v34 offset:4096
    ds_read_b128 v[124:127], v35 offset:4096
    ds_read_b128 v[128:131], v32 offset:8192
    ds_read_b128 v[132:135], v33 offset:8192
    ds_read_b128 v[136:139], v34 offset:8192
    ds_read_b128 v[140:143], v35 offset:8192
    ds_read_b128 v[144:147], v32 offset:12288
    ds_read_b128 v[148:151], v33 offset:12288
    ds_read_b128 v[152:155], v34 offset:12288
    ds_read_b128 v[156:159], v35 offset:12288
    s_waitcnt vmcnt(0)
    s_branch L_gq_4_chk
L_gq_4:
    global_load_dwordx4 v[16:19], v86, s[26:27] sc1
    global_load_dwordx4 v[20:23], v86, s[26:27] offset:2048 sc1
    s_waitcnt vmcnt(0)
L_gq_4_chk:
    v_xor_b32 v3, v16, v2
    v_bitop3_b32 v3, v3, v17, v2 bitop3:0xF6
    v_bitop3_b32 v3, v3, v18, v2 bitop3:0xF6
    v_bitop3_b32 v3, v3, v19, v2 bitop3:0xF6
    v_bitop3_b32 v3, v3, v20, v2 bitop3:0xF6
    v_bitop3_b32 v3, v3, v21, v2 bitop3:0xF6
    v_bitop3_b32 v3, v3, v22, v2 bitop3:0xF6
    v_bitop3_b32 v3, v3, v23, v2 bitop3:0xF6
    v_and_b32 v3, 0xff, v3
    v_cmp_ne_u32 vcc, 0, v3
    s_cbranch_vccz L_gq_4_ok
    s_sleep 8
    s_add_u32 s66, s66, 1
    s_cmp_lt_u32 s66, 30000
    s_cbranch_scc1 L_gq_4
L_gq_4_ok:
    v_mov_b32 v2, s33
    s_lshl_b32 s36, s28, 9
    s_add_u32 s36, s36, 327680
    v_and_b32 v84, 31, v1
    v_lshlrev_b32 v84, 4, v84
    v_add_u32 v84, s36, v84
    global_load_dwordx4 v[92:95], v84, s[26:27] sc1
    v_add_f32 v16, v16, v20
    v_add_f32 v17, v17, v21
    v_add_f32 v18, v18, v22
    v_add_f32 v19, v19, v23
    s_nop 0
    v_permlane32_swap_b32 v16, v18
    v_permlane32_swap_b32 v17, v19
    v_add_f32 v16, v16, v18
    v_add_f32 v17, v17, v19
    v_cvt_pk_bf16_f32 v16, v16, v17
    ds_write_b32 v87, v16
    ds_write_b32 v39, v6
L_fw_6:
    ds_read_b128 v[88:91], v5 offset:16
    s_waitcnt lgkmcnt(0)
    v_min3_u32 v88, v88, v89, v90
    v_min_u32 v88, v88, v91
    s_nop 0
    v_readfirstlane_b32 s67, v88
    s_nop 0
    s_cmp_ge_u32 s67, 1
    s_cbranch_scc0 L_fw_6
    ds_read_b128 v[16:19], v38 offset:0
    ds_read_b128 v[20:23], v38 offset:64
    ds_read_b128 v[24:27], v38 offset:128
    ds_read_b128 v[28:31], v38 offset:192
    s_waitcnt lgkmcnt(0)
    v_mfma_f32_16x16x32_bf16 v[40:43], v[96:99], v[16:19], v[40:43]
    v_mfma_f32_16x16x32_bf16 v[44:47], v[112:115], v[16:19], v[44:47]
    v_mfma_f32_16x16x32_bf16 v[48:51], v[128:131], v[16:19], v[48:51]
    v_mfma_f32_16x16x32_bf16 v[52:55], v[144:147], v[16:19], v[52:55]
    v_mfma_f32_16x16x32_bf16 v[40:43], v[100:103], v[20:23], v[40:43]
    v_mfma_f32_16x16x32_bf16 v[44:47], v[116:119], v[20:23], v[44:47]
    v_mfma_f32_16x16x32_bf16 v[48:51], v[132:135], v[20:23], v[48:51]
    v_mfma_f32_16x16x32_bf16 v[52:55], v[148:151], v[20:23], v[52:55]
    v_mfma_f32_16x16x32_bf16 v[40:43], v[104:107], v[24:27], v[40:43]
    v_mfma_f32_16x16x32_bf16 v[44:47], v[120:123], v[24:27], v[44:47]
    v_mfma_f32_16x16x32_bf16 v[48:51], v[136:139], v[24:27], v[48:51]
    v_mfma_f32_16x16x32_bf16 v[52:55], v[152:155], v[24:27], v[52:55]
    v_mfma_f32_16x16x32_bf16 v[40:43], v[108:111], v[28:31], v[40:43]
    v_mfma_f32_16x16x32_bf16 v[44:47], v[124:127], v[28:31], v[44:47]
    v_mfma_f32_16x16x32_bf16 v[48:51], v[140:143], v[28:31], v[48:51]
    v_mfma_f32_16x16x32_bf16 v[52:55], v[156:159], v[28:31], v[52:55]
    s_nop 5
    v_mov_b32_dpp v40, v44 row_shr:4 row_mask:0xf bank_mask:0x2
    v_mov_b32_dpp v41, v45 row_shr:4 row_mask:0xf bank_mask:0x2
    v_mov_b32_dpp v42, v46 row_shr:4 row_mask:0xf bank_mask:0x2
    v_mov_b32_dpp v43, v47 row_shr:4 row_mask:0xf bank_mask:0x2
    v_mov_b32_dpp v40, v48 row_shr:8 row_mask:0xf bank_mask:0x4
    v_mov_b32_dpp v41, v49 row_shr:8 row_mask:0xf bank_mask:0x4
    v_mov_b32_dpp v42, v50 row_shr:8 row_mask:0xf bank_mask:0x4
    v_mov_b32_dpp v43, v51 row_shr:8 row_mask:0xf bank_mask:0x4
    v_mov_b32_dpp v40, v52 row_shr:12 row_mask:0xf bank_mask:0x8
    v_mov_b32_dpp v41, v53 row_shr:12 row_mask:0xf bank_mask:0x8
    v_mov_b32_dpp v42, v54 row_shr:12 row_mask:0xf bank_mask:0x8
    v_mov_b32_dpp v43, v55 row_shr:12 row_mask:0xf bank_mask:0x8
    v_max3_f32 v56, v40, v41, v42
    v_max_f32 v56, v56, v43
    s_nop 1
    v_max_f32_dpp v56, v56, v56 row_ror:4 row_mask:0xf bank_mask:0xf
    s_nop 1
    v_max_f32_dpp v56, v56, v56 row_ror:8 row_mask:0xf bank_mask:0xf
    v_mov_b32 v57, v56
    s_nop 1
    v_permlane16_swap_b32 v56, v57
    v_max_f32 v56, v56, v57
    v_mov_b32 v57, v56
    s_nop 1
    v_permlane32_swap_b32 v56, v57
    v_max_f32 v56, v56, v57
    v_min_u32 v56, -2, v56
    s_mov_b64 exec, 15
    ds_write_b32 v59, v56
    s_mov_b64 exec, -1
L_vw_7:
    ds_read_b128 v[60:63], v58 offset:0
    s_waitcnt lgkmcnt(0)
    v_max3_u32 v88, v60, v61, v62
    v_max_u32 v88, v88, v63
    v_cmp_eq_u32 vcc, -1, v88
    s_cbranch_vccnz L_vw_7
    v_max3_f32 v56, v60, v61, v62
    v_max_f32 v56, v56, v63
    v_sub_f32 v40, v40, v56
    v_sub_f32 v41, v41, v56
    v_sub_f32 v42, v42, v56
    v_sub_f32 v43, v43, v56
    v_exp_f32 v40, v40
    v_exp_f32 v41, v41
    v_exp_f32 v42, v42
    v_exp_f32 v43, v43
    v_add_f32 v57, v40, v41
    v_add_f32 v60, v42, v43
    v_cvt_pk_bf16_f32 v64, v40, v41
    v_cvt_pk_bf16_f32 v65, v42, v43
    v_add_f32 v57, v57, v60
    ds_write_b64 v36, v[64:65]
    s_nop 0
    v_add_f32_dpp v57, v57, v57 row_ror:4 row_mask:0xf bank_mask:0xf
    s_nop 1
    v_add_f32_dpp v57, v57, v57 row_ror:8 row_mask:0xf bank_mask:0xf
    v_mov_b32 v60, v57
    s_nop 1
    v_permlane16_swap_b32 v57, v60
    v_add_f32 v57, v57, v60
    v_mov_b32 v60, v57
    s_nop 1
    v_permlane32_swap_b32 v57, v60
    v_add_f32 v57, v57, v60
    v_min_u32 v57, -2, v57
    s_mov_b64 exec, 15
    ds_write_b32 v59, v57 offset:64
    s_mov_b64 exec, -1
L_vw_8:
    ds_read_b128 v[60:63], v58 offset:64
    s_waitcnt lgkmcnt(0)
    v_max3_u32 v88, v60, v61, v62
    v_max_u32 v88, v88, v63
    v_cmp_eq_u32 vcc, -1, v88
    s_cbranch_vccnz L_vw_8
    ds_read_b128 v[96:99], v244
    ds_read_b128 v[100:103], v245
    ds_read_b128 v[104:107], v246
    ds_read_b128 v[108:111], v247
    ds_read_b128 v[112:115], v248
    ds_read_b128 v[116:119], v249
    ds_read_b128 v[120:123], v250
    ds_read_b128 v[124:127], v251
    s_cmp_eq_u32 s32, 0
    s_cbranch_scc0 L_nolse
    v_add_f32 v60, v60, v61
    v_add_f32 v62, v62, v63
    v_add_f32 v60, v60, v62
    v_perm_b32 v68, v56, v2, s35
    v_perm_b32 v69, v60, v2, s35
    s_lshl_b32 s36, s28, 11
    s_lshl_b32 s37, s29, 4
    s_add_u32 s36, s36, s37
    s_add_u32 s36, s36, 335872
    v_lshlrev_b32 v62, 9, v1
    v_add_u32 v62, s36, v62
    v_mov_b32 v70, v68
    v_mov_b32 v71, v69
    s_mov_b64 exec, 15
    global_store_dwordx4 v62, v[68:71], s[26:27] sc1
    s_mov_b64 exec, -1
L_nolse:
    s_waitcnt vmcnt(0)
    v_xor_b32 v84, s38, v92
    v_bitop3_b32 v84, v84, v93, s38 bitop3:0xF6
    v_bitop3_b32 v84, v84, v94, s38 bitop3:0xF6
    v_bitop3_b32 v84, v84, v95, s38 bitop3:0xF6
    v_cmp_ne_u32 vcc, 0, v84
    s_nop 0
    s_cmp_eq_u64 vcc, 0
    s_cselect_b32 s69, 1, 0
    s_mov_b32 s68, 0
    s_cmp_ge_u32 s68, 4
    s_cbranch_scc1 L_en_9
L_wp_10:
    ds_read_b128 v[88:91], v5
    s_waitcnt lgkmcnt(0)
    v_min3_u32 v88, v88, v89, v90
    v_min_u32 v88, v88, v91
    s_nop 0
    v_readfirstlane_b32 s67, v88
    s_nop 0
    s_cmp_ge_u32 s67, 4
    s_cbranch_scc0 L_wp_10
    s_mov_b32 s68, s67
L_en_9:
    ds_read_b64_tr_b16 v[180:181], v164
    ds_read_b64_tr_b16 v[182:183], v164 offset:1024
    ds_read_b64_tr_b16 v[184:185], v165
    ds_read_b64_tr_b16 v[186:187], v165 offset:1024
    ds_read_b64_tr_b16 v[188:189], v166
    ds_read_b64_tr_b16 v[190:191], v166 offset:1024
    ds_read_b64_tr_b16 v[192:193], v167
    ds_read_b64_tr_b16 v[194:195], v167 offset:1024
    ds_read_b64_tr_b16 v[196:197], v168
    ds_read_b64_tr_b16 v[198:199], v168 offset:1024
    ds_read_b64_tr_b16 v[200:201], v169
    ds_read_b64_tr_b16 v[202:203], v169 offset:1024
    s_waitcnt lgkmcnt(8)
    v_mfma_f32_16x16x32_bf16 v[76:79], v[180:183], v[96:99], v[76:79]
    v_mfma_f32_16x16x32_bf16 v[80:83], v[184:187], v[96:99], v[80:83]
    ds_read_b64_tr_b16 v[204:205], v170
    ds_read_b64_tr_b16 v[206:207], v170 offset:1024
    ds_read_b64_tr_b16 v[208:209], v171
    ds_read_b64_tr_b16 v[210:211], v171 offset:1024
    s_waitcnt lgkmcnt(8)
    v_mfma_f32_16x16x32_bf16 v[76:79], v[188:191], v[100:103], v[76:79]
    v_mfma_f32_16x16x32_bf16 v[80:83], v[192:195], v[100:103], v[80:83]
    s_cmp_ge_u32 s68, 5
    s_cbranch_scc1 L_en_11
L_wp_12:
    ds_read_b128 v[88:91], v5
    s_waitcnt lgkmcnt(0)
    v_min3_u32 v88, v88, v89, v90
    v_min_u32 v88, v88, v91
    s_nop 0
    v_readfirstlane_b32 s67, v88
    s_nop 0
    s_cmp_ge_u32 s67, 5
    s_cbranch_scc0 L_wp_12
    s_mov_b32 s68, s67
L_en_11:
    ds_read_b64_tr_b16 v[212:213], v172
    ds_read_b64_tr_b16 v[214:215], v172 offset:1024
    ds_read_b64_tr_b16 v[216:217], v173
    ds_read_b64_tr_b16 v[218:219], v173 offset:1024
    s_waitcnt lgkmcnt(8)
    v_mfma_f32_16x16x32_bf16 v[76:79], v[196:199], v[104:107], v[76:79]
    v_mfma_f32_16x16x32_bf16 v[80:83], v[200:203], v[104:107], v[80:83]
    ds_read_b64_tr_b16 v[220:221], v174
    ds_read_b64_tr_b16 v[222:223], v174 offset:1024
    ds_read_b64_tr_b16 v[224:225], v175
    ds_read_b64_tr_b16 v[226:227], v175 offset:1024
    s_waitcnt lgkmcnt(8)
    v_mfma_f32_16x16x32_bf16 v[76:79], v[204:207], v[108:111], v[76:79]
    v_mfma_f32_16x16x32_bf16 v[80:83], v[208:211], v[108:111], v[80:83]
    s_cmp_ge_u32 s68, 6
    s_cbranch_scc1 L_en_13
L_wp_14:
    ds_read_b128 v[88:91], v5
    s_waitcnt lgkmcnt(0)
    v_min3_u32 v88, v88, v89, v90
    v_min_u32 v88, v88, v91
    s_nop 0
    v_readfirstlane_b32 s67, v88
    s_nop 0
    s_cmp_ge_u32 s67, 6
    s_cbranch_scc0 L_wp_14
    s_mov_b32 s68, s67
L_en_13:
    ds_read_b64_tr_b16 v[228:229], v176
    ds_read_b64_tr_b16 v[230:231], v176 offset:1024
    ds_read_b64_tr_b16 v[232:233], v177
    ds_read_b64_tr_b16 v[234:235], v177 offset:1024
    s_waitcnt lgkmcnt(8)
    v_mfma_f32_16x16x32_bf16 v[76:79], v[212:215], v[112:115], v[76:79]
    v_mfma_f32_16x16x32_bf16 v[80:83], v[216:219], v[112:115], v[80:83]
    s_waitcnt lgkmcnt(4)
    v_mfma_f32_16x16x32_bf16 v[76:79], v[220:223], v[116:119], v[76:79]
    v_mfma_f32_16x16x32_bf16 v[80:83], v[224:227], v[116:119], v[80:83]
    s_barrier
    ds_read_b64_tr_b16 v[236:237], v178
    ds_read_b64_tr_b16 v[238:239], v178 offset:1024
    ds_read_b64_tr_b16 v[240:241], v179
    ds_read_b64_tr_b16 v[242:243], v179 offset:1024
    s_waitcnt lgkmcnt(4)
    v_mfma_f32_16x16x32_bf16 v[76:79], v[228:231], v[120:123], v[76:79]
    v_mfma_f32_16x16x32_bf16 v[80:83], v[232:235], v[120:123], v[80:83]
    s_waitcnt lgkmcnt(0)
    v_mfma_f32_16x16x32_bf16 v[76:79], v[236:239], v[124:127], v[76:79]
    v_mfma_f32_16x16x32_bf16 v[80:83], v[240:243], v[124:127], v[80:83]
    s_mov_b64 exec, s[70:71]
    s_nop 5
    ds_write_b128 v66, v[76:79]
    ds_write_b128 v66, v[80:83] offset:64
    s_mov_b64 exec, -1
    ds_read_b128 v[76:79], v67
    s_waitcnt lgkmcnt(0)
    v_perm_b32 v76, v76, v2, s35
    v_perm_b32 v77, v77, v2, s35
    v_perm_b32 v78, v78, v2, s35
    v_perm_b32 v79, v79, v2, s35
    s_mov_b32 exec_hi, 0
    s_cmp_eq_u32 s69, 1
    s_cbranch_scc0 L_opub_wt
    global_store_dwordx4 v75, v[76:79], s[26:27]
    s_branch L_opub_done
L_opub_wt:
    global_store_dwordx4 v75, v[76:79], s[26:27] sc1
L_opub_done:
    s_mov_b64 exec, -1
    s_lshl_b32 s40, s28, 2
    s_add_u32 s40, s40, s30
    s_lshl_b32 s41, s40, 14
    s_lshl_b32 s42, s32, 7
    s_add_u32 s41, s41, s42
    s_add_u32 s41, s41, 524288
    v_and_b32 v11, 7, v1
    v_bfe_u32 v12, v1, 3, 2
    v_lshrrev_b32 v13, 5, v1
    v_lshlrev_b32 v44, 12, v12
    v_lshl_add_u32 v44, v13, 11, v44
    v_lshl_add_u32 v44, v11, 4, v44
    v_add_u32 v44, s41, v44
    s_lshl_b32 s41, s28, 11
    s_lshl_b32 s42, s30, 9
    s_add_u32 s41, s41, s42
    s_add_u32 s41, s41, 335872
    v_lshlrev_b32 v45, 7, v12
    v_lshl_add_u32 v45, v13, 6, v45
    v_add_u32 v45, s41, v45
    global_load_dwordx4 v[52:55], v45, s[26:27] offset:0 sc1
    global_load_dwordx4 v[56:59], v45, s[26:27] offset:16 sc1
    global_load_dwordx4 v[60:63], v45, s[26:27] offset:32 sc1
    global_load_dwordx4 v[64:67], v45, s[26:27] offset:48 sc1
    s_lshl_b32 s41, s40, 17
    s_lshl_b32 s42, s31, 7
    s_add_u32 s41, s41, s42
    s_add_u32 s44, s12, s41
    s_addc_u32 s45, s13, 0
    s_sub_u32 s46, 4194304, s41
    s_mov_b32 s47, 0x20000
    v_lshrrev_b32 v46, 3, v1
    v_and_b32 v47, 7, v1
    v_bfe_u32 v48, v1, 4, 1
    v_lshlrev_b32 v48, 1, v48
    v_xor_b32 v47, v47, v48
    v_lshlrev_b32 v46, 10, v46
    v_lshl_add_u32 v49, v47, 4, v46
    v_xor_b32 v47, 4, v47
    v_lshl_add_u32 v50, v47, 4, v46
    s_lshl_b32 s42, s32, 15
    s_lshl_b32 s43, s32, 12
    s_add_u32 s43, s43, 131072
    s_add_u32 s48, s42, 0
    s_add_u32 m0, s43, 0
    s_nop 0
    buffer_load_dwordx4 v49, s[44:47], s48 offen nt lds
    s_add_u32 s48, s42, 8192
    s_add_u32 m0, s43, 1024
    s_nop 0
    buffer_load_dwordx4 v50, s[44:47], s48 offen nt lds
    s_add_u32 s48, s42, 16384
    s_add_u32 m0, s43, 2048
    s_nop 0
    buffer_load_dwordx4 v49, s[44:47], s48 offen nt lds
    s_add_u32 s48, s42, 24576
    s_add_u32 m0, s43, 3072
    s_nop 0
    buffer_load_dwordx4 v50, s[44:47], s48 offen nt lds
    v_mul_u32_u24 v12, 272, v12
    v_lshl_add_u32 v12, v11, 3, v12
    v_lshrrev_b32 v13, 5, v1
    v_lshl_add_u32 v12, v13, 2, v12
    s_lshl_b32 s41, s32, 6
    s_add_u32 s41, s41, 155776
    v_add_u32 v12, s41, v12
    v_and_b32 v51, 3, v7
    v_mul_u32_u24 v51, 272, v51
    v_lshl_add_u32 v51, v8, 4, v51
    v_add_u32 v51, 155776, v51
    s_lshl_b32 s41, s31, 10
    s_lshl_b32 s42, s40, 13
    s_add_u32 s41, s41, s42
    s_lshl_b32 s42, s32, 8
    s_add_u32 s41, s41, s42
    s_add_u32 s41, s41, 65536
    v_lshlrev_b32 v50, 4, v7
    v_lshl_add_u32 v50, v8, 6, v50
    v_add_u32 v50, s41, v50
    s_cmp_eq_u32 s69, 1
    s_cbranch_scc1 L_ga_16_near
    s_sleep 10
L_ga_16_near:
    s_sleep 12
    global_load_dwordx4 v[16:19], v44, s[26:27] offset:0 sc1
    global_load_dwordx4 v[20:23], v44, s[26:27] offset:512 sc1
    global_load_dwordx4 v[24:27], v44, s[26:27] offset:1024 sc1
    global_load_dwordx4 v[28:31], v44, s[26:27] offset:1536 sc1
    s_waitcnt vmcnt(8)
    s_branch L_gl_15_chk
L_gl_15:
    global_load_dwordx4 v[52:55], v45, s[26:27] offset:0 sc1
    global_load_dwordx4 v[56:59], v45, s[26:27] offset:16 sc1
    global_load_dwordx4 v[60:63], v45, s[26:27] offset:32 sc1
    global_load_dwordx4 v[64:67], v45, s[26:27] offset:48 sc1
    s_waitcnt vmcnt(0)
L_gl_15_chk:
    v_xor_b32 v3, v52, v2
    v_bitop3_b32 v3, v3, v53, v2 bitop3:0xF6
    v_bitop3_b32 v3, v3, v54, v2 bitop3:0xF6
    v_bitop3_b32 v3, v3, v55, v2 bitop3:0xF6
    v_bitop3_b32 v3, v3, v56, v2 bitop3:0xF6
    v_bitop3_b32 v3, v3, v57, v2 bitop3:0xF6
    v_bitop3_b32 v3, v3, v58, v2 bitop3:0xF6
    v_bitop3_b32 v3, v3, v59, v2 bitop3:0xF6
    v_bitop3_b32 v3, v3, v60, v2 bitop3:0xF6
    v_bitop3_b32 v3, v3, v61, v2 bitop3:0xF6
    v_bitop3_b32 v3, v3, v62, v2 bitop3:0xF6
    v_bitop3_b32 v3, v3, v63, v2 bitop3:0xF6
    v_bitop3_b32 v3, v3, v64, v2 bitop3:0xF6
    v_bitop3_b32 v3, v3, v65, v2 bitop3:0xF6
    v_bitop3_b32 v3, v3, v66, v2 bitop3:0xF6
    v_bitop3_b32 v3, v3, v67, v2 bitop3:0xF6
    v_and_b32 v3, 0xff, v3
    v_cmp_ne_u32 vcc, 0, v3
    s_cbranch_vccz L_gl_15_ok
    s_sleep 4
    s_add_u32 s66, s66, 1
    s_cmp_lt_u32 s66, 30000
    s_cbranch_scc1 L_gl_15
L_gl_15_ok:
    v_max3_f32 v36, v52, v56, v60
    v_max_f32 v36, v36, v64
    v_mov_b32 v37, v36
    s_nop 1
    v_permlane32_swap_b32 v36, v37
    v_max_f32 v36, v36, v37
    v_sub_f32 v32, v52, v36
    v_sub_f32 v33, v56, v36
    v_sub_f32 v34, v60, v36
    v_sub_f32 v35, v64, v36
    v_exp_f32 v32, v32
    v_exp_f32 v33, v33
    v_exp_f32 v34, v34
    v_exp_f32 v35, v35
    v_mul_f32 v36, v32, v53
    v_fmac_f32 v36, v33, v57
    v_fmac_f32 v36, v34, v61
    v_fmac_f32 v36, v35, v65
    v_mov_b32 v37, v36
    s_nop 1
    v_permlane32_swap_b32 v36, v37
    v_add_f32 v36, v36, v37
    v_rcp_f32 v36, v36
    s_nop 0
    v_mul_f32 v32, v36, v32
    v_mul_f32 v33, v36, v33
    v_mul_f32 v34, v36, v34
    v_mul_f32 v35, v36, v35
    v_mov_b32 v64, 0
    v_mov_b32 v65, 0
    v_mov_b32 v66, 0
    v_mov_b32 v67, 0
    s_waitcnt vmcnt(4)
    s_barrier
    ds_read_b64_tr_b16 v[96:97], v10 offset:0
    ds_read_b64_tr_b16 v[98:99], v10 offset:512
    ds_read_b64_tr_b16 v[100:101], v10 offset:4096
    ds_read_b64_tr_b16 v[102:103], v10 offset:4608
    ds_read_b64_tr_b16 v[104:105], v10 offset:8192
    ds_read_b64_tr_b16 v[106:107], v10 offset:8704
    ds_read_b64_tr_b16 v[108:109], v10 offset:12288
    ds_read_b64_tr_b16 v[110:111], v10 offset:12800
    s_waitcnt vmcnt(0)
    s_branch L_ga_16_chk
L_ga_16:
    global_load_dwordx4 v[16:19], v44, s[26:27] offset:0 sc1
    global_load_dwordx4 v[20:23], v44, s[26:27] offset:512 sc1
    global_load_dwordx4 v[24:27], v44, s[26:27] offset:1024 sc1
    global_load_dwordx4 v[28:31], v44, s[26:27] offset:1536 sc1
    s_waitcnt vmcnt(0)
L_ga_16_chk:
    v_xor_b32 v3, v16, v2
    v_bitop3_b32 v3, v3, v17, v2 bitop3:0xF6
    v_bitop3_b32 v3, v3, v18, v2 bitop3:0xF6
    v_bitop3_b32 v3, v3, v19, v2 bitop3:0xF6
    v_bitop3_b32 v3, v3, v20, v2 bitop3:0xF6
    v_bitop3_b32 v3, v3, v21, v2 bitop3:0xF6
    v_bitop3_b32 v3, v3, v22, v2 bitop3:0xF6
    v_bitop3_b32 v3, v3, v23, v2 bitop3:0xF6
    v_bitop3_b32 v3, v3, v24, v2 bitop3:0xF6
    v_bitop3_b32 v3, v3, v25, v2 bitop3:0xF6
    v_bitop3_b32 v3, v3, v26, v2 bitop3:0xF6
    v_bitop3_b32 v3, v3, v27, v2 bitop3:0xF6
    v_bitop3_b32 v3, v3, v28, v2 bitop3:0xF6
    v_bitop3_b32 v3, v3, v29, v2 bitop3:0xF6
    v_bitop3_b32 v3, v3, v30, v2 bitop3:0xF6
    v_bitop3_b32 v3, v3, v31, v2 bitop3:0xF6
    v_and_b32 v3, 0xff, v3
    v_cmp_ne_u32 vcc, 0, v3
    s_cbranch_vccz L_ga_16_ok
    s_sleep 4
    s_add_u32 s66, s66, 1
    s_cmp_lt_u32 s66, 30000
    s_cbranch_scc1 L_ga_16
L_ga_16_ok:
    v_mul_f32 v40, v32, v16
    v_mul_f32 v41, v32, v17
    v_mul_f32 v42, v32, v18
    v_mul_f32 v43, v32, v19
    v_fmac_f32 v40, v33, v20
    v_fmac_f32 v41, v33, v21
    v_fmac_f32 v42, v33, v22
    v_fmac_f32 v43, v33, v23
    v_fmac_f32 v40, v34, v24
    v_fmac_f32 v41, v34, v25
    v_fmac_f32 v42, v34, v26
    v_fmac_f32 v43, v34, v27
    v_fmac_f32 v40, v35, v28
    v_fmac_f32 v41, v35, v29
    v_fmac_f32 v42, v35, v30
    v_fmac_f32 v43, v35, v31
    s_nop 0
    v_permlane32_swap_b32 v40, v42
    v_permlane32_swap_b32 v41, v43
    v_add_f32 v40, v40, v42
    v_add_f32 v41, v41, v43
    v_cvt_pk_bf16_f32 v40, v40, v41
    ds_write_b32 v12, v40
    s_waitcnt lgkmcnt(0)
L_tail_entry:
    s_barrier
    s_cmp_ge_u32 s32, 4
    s_cbranch_scc1 L_s2_done
    ds_read_b128 v[16:19], v51 offset:0
    ds_read_b128 v[20:23], v51 offset:64
    ds_read_b128 v[24:27], v51 offset:128
    ds_read_b128 v[28:31], v51 offset:192
    s_waitcnt lgkmcnt(0)
    v_mfma_f32_16x16x32_bf16 v[64:67], v[96:99], v[16:19], v[64:67]
    v_mfma_f32_16x16x32_bf16 v[64:67], v[100:103], v[20:23], v[64:67]
    v_mfma_f32_16x16x32_bf16 v[64:67], v[104:107], v[24:27], v[64:67]
    v_mfma_f32_16x16x32_bf16 v[64:67], v[108:111], v[28:31], v[64:67]
    s_nop 7
    v_perm_b32 v64, v64, v2, s35
    v_perm_b32 v65, v65, v2, s35
    v_perm_b32 v66, v66, v2, s35
    v_perm_b32 v67, v67, v2, s35
    s_mov_b64 exec, s[70:71]
    global_store_dwordx4 v50, v[64:67], s[26:27] sc1
    s_mov_b64 exec, -1
L_s2_done:
    s_cmp_lt_u32 s32, 4
    s_cbranch_scc1 L_have_tag
    s_waitcnt lgkmcnt(0)
    s_add_u32 s34, s34, 1
    s_and_b32 s33, s34, 0xff
    v_mov_b32 v2, s33
    v_and_b32 v7, 15, v1
    v_lshrrev_b32 v8, 4, v1
L_have_tag:
    s_cmp_ge_u32 s29, 28
    s_cbranch_scc1 L_final
    s_mul_i32 s43, s28, 7
    s_lshr_b32 s42, s29, 2
    s_add_u32 s43, s43, s42
    s_and_b32 s40, s29, 3
    s_cmp_ge_u32 s32, 4
    s_cbranch_scc1 L_nodma
    s_mul_i32 s41, s28, 229376
    s_lshl_b32 s42, s29, 7
    s_add_u32 s41, s41, s42
    s_add_u32 s44, s16, s41
    s_addc_u32 s45, s17, 0
    s_sub_u32 s46, 1835008, s41
    s_mov_b32 s47, 0x20000
    s_add_u32 s48, s18, s41
    s_addc_u32 s49, s19, 0
    s_sub_u32 s50, 1835008, s41
    s_mov_b32 s51, 0x20000
    v_lshrrev_b32 v11, 3, v1
    v_and_b32 v12, 7, v1
    v_bfe_u32 v13, v1, 4, 1
    v_lshlrev_b32 v13, 1, v13
    v_xor_b32 v12, v12, v13
    v_mul_u32_u24 v11, 3584, v11
    v_lshl_add_u32 v14, v12, 4, v11
    v_xor_b32 v12, 4, v12
    v_lshl_add_u32 v15, v12, 4, v11
    s_and_b32 s53, s32, 3
    s_mul_i32 s52, s53, 57344
    s_lshl_b32 s53, s53, 11
    s_add_u32 s54, s52, 0
    s_add_u32 m0, s53, 0
    s_nop 0
    buffer_load_dwordx4 v14, s[44:47], s54 offen nt lds
    s_add_u32 s54, s52, 28672
    s_add_u32 m0, s53, 1024
    s_nop 0
    buffer_load_dwordx4 v15, s[44:47], s54 offen nt lds
    s_add_u32 s54, s52, 0
    s_add_u32 m0, s53, 8192
    s_nop 0
    buffer_load_dwordx4 v14, s[48:51], s54 offen nt lds
    s_add_u32 s54, s52, 28672
    s_add_u32 m0, s53, 9216
    s_nop 0
    buffer_load_dwordx4 v15, s[48:51], s54 offen nt lds
L_nodma:
    s_cmp_eq_u32 s32, 4
    s_cbranch_scc0 L_notouch2
    s_mul_i32 s52, s43, 10240
    s_mul_i32 s53, s40, 2560
    s_add_u32 s52, s52, s53
    s_add_u32 s52, s52, 1310720
    v_lshlrev_b32 v12, 6, v1
    v_add_u32 v13, s52, v12
    s_lshl_b32 s52, s43, 10
    s_lshl_b32 s53, s40, 8
    s_add_u32 s52, s52, s53
    s_add_u32 s52, s52, 1966080 - 2560
    v_add_u32 v14, s52, v12
    v_cmp_gt_u32 vcc, 40, v1
    s_nop 1
    v_cndmask_b32 v13, v14, v13, vcc
    v_cmp_gt_u32 vcc, 44, v1
    s_nop 0
    s_and_saveexec_b64 s[36:37], vcc
    global_load_dword v160, v13, s[26:27] sc1
    s_mov_b64 exec, s[36:37]
L_notouch2:
    s_lshl_b32 s41, s28, 10
    s_lshl_b32 s42, s32, 7
    s_add_u32 s41, s41, s42
    s_add_u32 s41, s41, 65536
    v_lshrrev_b32 v11, 3, v1
    v_and_b32 v12, 7, v1
    v_lshlrev_b32 v11, 13, v11
    v_lshl_add_u32 v11, v12, 4, v11
    v_add_u32 v40, s41, v11
    v_add_u32 v41, 0x10000, v40
    v_add_u32 v42, 0x20000, v40
    v_add_u32 v43, 0x30000, v40
    v_and_b32 v13, 3, v1
    v_bfe_u32 v14, v1, 2, 1
    v_lshlrev_b32 v14, 3, v14
    v_lshl_add_u32 v14, v8, 1, v14
    v_lshl_add_u32 v15, v13, 10, v14
    s_lshl_b32 s41, s28, 7
    s_lshl_b32 s42, s32, 4
    s_add_u32 s41, s41, s42
    s_add_u32 s41, s41, 147456
    v_add_u32 v15, s41, v15
    ds_read_u16 v44, v15
    v_mul_u32_u24 v11, 144, v13
    v_add_u32 v11, v14, v11
    s_add_u32 s42, s42, 156864
    v_add_u32 v11, s42, v11
    v_bfe_u32 v20, v1, 2, 2
    v_and_b32 v21, 3, v1
    v_lshl_add_u32 v46, v8, 3, v20
    v_lshlrev_b32 v46, 7, v46
    v_lshrrev_b32 v23, 1, v20
    v_and_b32 v24, 1, v8
    v_lshl_add_u32 v23, v24, 1, v23
    v_lshlrev_b32 v23, 1, v23
    v_lshrrev_b32 v24, 1, v21
    s_and_b32 s41, s32, 3
    s_lshl_b32 s42, s41, 1
    v_add_u32 v24, s42, v24
    v_xor_b32 v24, v24, v23
    v_lshl_add_u32 v46, v24, 4, v46
    v_and_b32 v21, 1, v21
    v_lshl_add_u32 v46, v21, 3, v46
    v_mov_b32 v20, 157888
    v_mov_b32 v21, 151552
    v_mul_u32_u24 v22, 144, v7
    v_add_u32 v22, 156864, v22
    v_cmp_eq_u32 vcc, 8, v7
    s_nop 1
    v_cndmask_b32 v47, v20, v21, vcc
    v_cmp_gt_u32 vcc, 4, v7
    s_nop 1
    v_cndmask_b32 v47, v47, v22, vcc
    v_lshl_add_u32 v47, v8, 4, v47
    v_cmp_eq_u32 vcc, 9, v7
    s_nop 1
    v_cndmask_b32 v48, v20, v21, vcc
    v_subrev_u32 v22, 576, v22
    v_lshrrev_b32 v23, 2, v7
    v_cmp_eq_u32 vcc, 1, v23
    s_nop 1
    v_cndmask_b32 v48, v48, v22, vcc
    v_lshl_add_u32 v48, v8, 4, v48
    s_lshl_b32 s52, s29, 2
    s_add_u32 s52, s52, s41
    s_mul_i32 s52, s52, 5120
    s_mul_i32 s53, s28, 640
    s_add_u32 s52, s52, s53
    s_add_u32 s52, s52, 1310720
    v_lshlrev_b32 v22, 4, v7
    v_lshl_add_u32 v23, v8, 7, v22
    v_lshl_add_u32 v24, v8, 5, v22
    v_add_u32 v24, 384, v24
    v_cmp_gt_u32 vcc, 8, v7
    s_nop 1
    v_cndmask_b32 v49, v24, v23, vcc
    v_add_u32 v49, s52, v49
    v_mov_b32 v64, 0
    v_mov_b32 v65, 0
    v_mov_b32 v66, 0
    v_mov_b32 v67, 0
    s_lshl_b32 s53, s29, 11
    s_lshl_b32 s54, s28, 7
    s_add_u32 s53, s53, s54
    s_add_u32 s53, s53, 1966080
    v_lshlrev_b32 v50, 4, v7
    v_add_u32 v50, s53, v50
    v_cmp_gt_u32 s[70:71], 10, v7
    v_cmp_eq_u32 s[60:61], 1, v7
    v_cmp_eq_u32 s[62:63], 2, v7
    v_cmp_eq_u32 s[64:65], 3, v7
    s_waitcnt lgkmcnt(0)
    v_lshlrev_b32 v44, 16, v44
    s_sleep 16
    global_load_dwordx4 v[16:19], v40, s[26:27] sc1
    global_load_dwordx4 v[20:23], v41, s[26:27] sc1
    global_load_dwordx4 v[24:27], v42, s[26:27] sc1
    global_load_dwordx4 v[28:31], v43, s[26:27] sc1
    s_waitcnt vmcnt(4)
    s_barrier
    s_cmp_ge_u32 s32, 4
    s_cbranch_scc1 L_gb_17_now
    ds_read_b64_tr_b16 v[96:97], v46 offset:0
    ds_read_b64_tr_b16 v[98:99], v46 offset:512
    ds_read_b64_tr_b16 v[104:105], v46 offset:8192
    ds_read_b64_tr_b16 v[106:107], v46 offset:8704
    ds_read_b64_tr_b16 v[100:101], v46 offset:4096
    ds_read_b64_tr_b16 v[102:103], v46 offset:4608
    ds_read_b64_tr_b16 v[108:109], v46 offset:12288
    ds_read_b64_tr_b16 v[110:111], v46 offset:12800
L_gb_17_now:
    s_waitcnt vmcnt(0)
    s_branch L_gb_17_chk
L_gb_17:
    global_load_dwordx4 v[16:19], v40, s[26:27] sc1
    global_load_dwordx4 v[20:23], v41, s[26:27] sc1
    global_load_dwordx4 v[24:27], v42, s[26:27] sc1
    global_load_dwordx4 v[28:31], v43, s[26:27] sc1
    s_waitcnt vmcnt(0)
L_gb_17_chk:
    v_xor_b32 v3, v16, v2
    v_bitop3_b32 v3, v3, v17, v2 bitop3:0xF6
    v_bitop3_b32 v3, v3, v18, v2 bitop3:0xF6
    v_bitop3_b32 v3, v3, v19, v2 bitop3:0xF6
    v_bitop3_b32 v3, v3, v20, v2 bitop3:0xF6
    v_bitop3_b32 v3, v3, v21, v2 bitop3:0xF6
    v_bitop3_b32 v3, v3, v22, v2 bitop3:0xF6
    v_bitop3_b32 v3, v3, v23, v2 bitop3:0xF6
    v_bitop3_b32 v3, v3, v24, v2 bitop3:0xF6
    v_bitop3_b32 v3, v3, v25, v2 bitop3:0xF6
    v_bitop3_b32 v3, v3, v26, v2 bitop3:0xF6
    v_bitop3_b32 v3, v3, v27, v2 bitop3:0xF6
    v_bitop3_b32 v3, v3, v28, v2 bitop3:0xF6
    v_bitop3_b32 v3, v3, v29, v2 bitop3:0xF6
    v_bitop3_b32 v3, v3, v30, v2 bitop3:0xF6
    v_bitop3_b32 v3, v3, v31, v2 bitop3:0xF6
    v_and_b32 v3, 0xff, v3
    v_cmp_ne_u32 vcc, 0, v3
    s_cbranch_vccz L_gb_17_ok
    s_sleep 4
    s_add_u32 s66, s66, 1
    s_cmp_lt_u32 s66, 30000
    s_cbranch_scc1 L_gb_17
L_gb_17_ok:
    v_add_f32 v16, v16, v20
    v_add_f32 v17, v17, v21
    v_add_f32 v18, v18, v22
    v_add_f32 v19, v19, v23
    v_add_f32 v24, v24, v28
    v_add_f32 v25, v25, v29
    v_add_f32 v26, v26, v30
    v_add_f32 v27, v27, v31
    v_add_f32 v16, v16, v24
    v_add_f32 v17, v17, v25
    v_add_f32 v18, v18, v26
    v_add_f32 v19, v19, v27
    v_permlane16_swap_b32 v16, v17
    s_nop 0
    v_permlane16_swap_b32 v18, v19
    v_add_f32 v16, v16, v17
    v_add_f32 v18, v18, v19
    s_nop 1
    v_permlane32_swap_b32 v16, v18
    v_add_f32 v16, v16, v18
    s_nop 1
    v_add_f32_dpp v16, v16, v16 row_ror:8 row_mask:0xf bank_mask:0xf
    v_add_f32 v16, v16, v44
    v_cvt_pk_bf16_f32 v16, v16, v16
    ds_write_b16 v11, v16
    s_waitcnt lgkmcnt(0)
    s_barrier
    s_cmp_gt_u32 s32, 4
    s_cbranch_scc1 L_s3a_done
    s_cmp_eq_u32 s32, 4
    s_cbranch_scc1 L_moments
    ds_read_b128 v[16:19], v47 offset:0
    ds_read_b128 v[24:27], v48 offset:0
    ds_read_b128 v[20:23], v47 offset:64
    ds_read_b128 v[28:31], v48 offset:64
    s_waitcnt lgkmcnt(0)
    v_mfma_f32_16x16x32_bf16 v[64:67], v[96:99], v[16:19], v[64:67]
    v_mfma_f32_16x16x32_bf16 v[64:67], v[100:103], v[20:23], v[64:67]
    v_mfma_f32_16x16x32_bf16 v[64:67], v[104:107], v[24:27], v[64:67]
    v_mfma_f32_16x16x32_bf16 v[64:67], v[108:111], v[28:31], v[64:67]
    s_nop 7
    v_perm_b32 v64, v64, v2, s35
    v_perm_b32 v65, v65, v2, s35
    v_perm_b32 v66, v66, v2, s35
    v_perm_b32 v67, v67, v2, s35
    s_mov_b64 exec, s[70:71]
    global_store_dwordx4 v49, v[64:67], s[26:27] sc1
    s_mov_b64 exec, -1
    s_mul_i32 s52, s28, 7
    s_lshr_b32 s53, s29, 2
    s_add_u32 s52, s52, s53
    s_lshl_b32 s52, s52, 15
    s_and_b32 s53, s29, 3
    s_lshl_b32 s53, s53, 8
    s_add_u32 s52, s52, s53
    s_add_u32 s56, s20, s52
    s_addc_u32 s57, s21, 0
    s_sub_u32 s58, 1835008, s52
    s_mov_b32 s59, 0x20000
    v_lshrrev_b32 v11, 4, v1
    v_and_b32 v12, 15, v1
    s_and_b32 s55, s32, 3
    s_and_b32 s54, s55, 1
    s_lshl_b32 s54, s54, 2
    v_add_u32 v13, s54, v11
    v_lshlrev_b32 v13, 1, v13
    v_xor_b32 v12, v12, v13
    v_lshlrev_b32 v11, 10, v11
    v_lshl_add_u32 v14, v12, 4, v11
    s_lshl_b32 s52, s55, 13
    s_lshl_b32 s53, s55, 11
    s_add_u32 s54, s52, 0
    s_add_u32 m0, s53, 16384
    s_nop 0
    buffer_load_dwordx4 v14, s[56:59], s54 offen nt lds
    s_add_u32 s54, s52, 4096
    s_add_u32 m0, s53, 17408
    s_nop 0
    buffer_load_dwordx4 v14, s[56:59], s54 offen nt lds
    s_branch L_nomom
L_moments:
    ds_read_b128 v[16:19], v47 offset:0
    ds_read_b128 v[20:23], v47 offset:64
    s_waitcnt lgkmcnt(0)
    v_mfma_f32_16x16x32_bf16 v[64:67], v[16:19], v[16:19], v[64:67]
    v_mfma_f32_16x16x32_bf16 v[64:67], v[20:23], v[20:23], v[64:67]
    s_nop 7
    v_mov_b32 v72, v64
    v_mov_b32 v73, v64
    v_cndmask_b32 v65, v64, v65, s[60:61]
    v_cndmask_b32 v65, v65, v66, s[62:63]
    v_cndmask_b32 v65, v65, v67, s[64:65]
    v_permlane32_swap_b32 v72, v73
    v_perm_b32 v65, v65, v2, s35
    v_perm_b32 v64, v73, v2, s35
    v_mov_b32 v67, v65
    v_mov_b32 v66, v64
    s_mov_b64 exec, 15
    global_store_dwordx4 v50, v[64:67], s[26:27] sc1
    global_store_dwordx4 v50, v[64:67], s[26:27] offset:1024 sc1
    s_mov_b64 exec, -1
L_nomom:
L_s3a_done:
    s_lshl_b32 s52, s43, 1
    s_lshr_b32 s53, s32, 2
    s_add_u32 s52, s52, s53
    s_mul_i32 s52, s52, 5120
    s_add_u32 s52, s52, 1310720
    s_and_b32 s53, s32, 3
    v_lshrrev_b32 v13, 3, v1
    v_mul_u32_u24 v12, 640, v13
    v_add_u32 v12, s52, v12
    v_and_b32 v11, 7, v1
    v_lshl_add_u32 v11, v11, 4, v12
    s_lshl_b32 s54, s53, 7
    v_add_u32 v11, s54, v11
    v_bfe_u32 v14, v1, 2, 1
    v_lshl_add_u32 v12, v14, 4, v12
    s_lshl_b32 s54, s53, 5
    s_add_u32 s54, s54, 512
    v_add_u32 v12, s54, v12
    s_lshl_b32 s52, s43, 10
    s_add_u32 s52, s52, 1966080
    v_and_b32 v14, 3, v1
    v_lshlrev_b32 v13, 7, v13
    v_lshl_add_u32 v13, v14, 4, v13
    v_add_u32 v13, s52, v13
    v_lshl_add_u32 v15, v14, 2, v13
    v_bfe_u32 v40, v1, 2, 2
    v_and_b32 v41, 3, v1
    v_lshl_add_u32 v42, v8, 3, v40
    v_lshlrev_b32 v42, 8, v42
    v_and_b32 v43, 1, v8
    v_lshl_add_u32 v43, v43, 2, v40
    v_lshlrev_b32 v43, 1, v43
    v_lshrrev_b32 v44, 1, v41
    s_lshl_b32 s52, s32, 1
    v_add_u32 v44, s52, v44
    v_xor_b32 v44, v44, v43
    v_lshl_add_u32 v42, v44, 4, v42
    v_and_b32 v41, 1, v41
    v_lshl_add_u32 v42, v41, 3, v42
    v_cmp_gt_u32 s[70:71], 4, v7
    v_and_b32 v57, 3, v1
    v_mul_u32_u24 v57, 80, v57
    v_lshl_add_u32 v57, v8, 1, v57
    s_lshl_b32 s52, s32, 3
    s_add_u32 s52, s52, 158912
    v_add_u32 v57, s52, v57
    v_min_u32 v58, 3, v7
    v_mul_u32_u24 v58, 80, v58
    v_lshl_add_u32 v58, v8, 4, v58
    v_add_u32 v58, 158912, v58
    s_mul_i32 s52, s40, 56
    s_add_u32 s52, s52, s43
    s_lshl_b32 s52, s52, 11
    s_lshl_b32 s53, s32, 8
    s_add_u32 s52, s52, s53
    s_add_u32 s52, s52, 2097152
    v_lshlrev_b32 v59, 4, v7
    v_lshl_add_u32 v59, v8, 6, v59
    v_add_u32 v59, s52, v59
    v_mov_b32 v64, 0
    v_mov_b32 v65, 0
    v_mov_b32 v66, 0
    v_mov_b32 v67, 0
    s_sleep 16
L_gg_18:
    global_load_dwordx4 v[16:19], v11, s[26:27] sc1
    global_load_dwordx4 v[20:23], v12, s[26:27] sc1
    global_load_dwordx4 v[24:27], v13, s[26:27] sc1
    s_waitcnt vmcnt(0)
    v_xor_b32 v3, v16, v2
    v_bitop3_b32 v3, v3, v17, v2 bitop3:0xF6
    v_bitop3_b32 v3, v3, v18, v2 bitop3:0xF6
    v_bitop3_b32 v3, v3, v19, v2 bitop3:0xF6
    v_bitop3_b32 v3, v3, v20, v2 bitop3:0xF6
    v_bitop3_b32 v3, v3, v21, v2 bitop3:0xF6
    v_bitop3_b32 v3, v3, v22, v2 bitop3:0xF6
    v_bitop3_b32 v3, v3, v23, v2 bitop3:0xF6
    v_bitop3_b32 v3, v3, v24, v2 bitop3:0xF6
    v_bitop3_b32 v3, v3, v25, v2 bitop3:0xF6
    v_bitop3_b32 v3, v3, v26, v2 bitop3:0xF6
    v_bitop3_b32 v3, v3, v27, v2 bitop3:0xF6
    v_and_b32 v3, 0xff, v3
    v_cmp_ne_u32 vcc, 0, v3
    s_cbranch_vccz L_gg_18_ok
    s_sleep 4
    s_add_u32 s66, s66, 1
    s_cmp_lt_u32 s66, 30000
    s_cbranch_scc1 L_gg_18
L_gg_18_ok:
    v_permlane16_swap_b32 v16, v17
    v_permlane16_swap_b32 v18, v19
    v_add_f32 v16, v16, v17
    v_add_f32 v18, v18, v19
    s_nop 1
    v_permlane32_swap_b32 v16, v18
    v_add_f32 v16, v16, v18
    v_permlane16_swap_b32 v20, v21
    v_permlane16_swap_b32 v22, v23
    v_add_f32 v20, v20, v21
    v_add_f32 v22, v22, v23
    s_nop 1
    v_permlane32_swap_b32 v20, v22
    v_add_f32 v20, v20, v22
    v_permlane16_swap_b32 v24, v25
    v_add_f32 v24, v24, v25
    v_mov_b32 v25, v24
    s_nop 1
    v_permlane32_swap_b32 v24, v25
    v_add_f32 v24, v24, v25
    v_add_f32_dpp v16, v16, v16 row_ror:8 row_mask:0xf bank_mask:0xf
    v_add_f32_dpp v20, v20, v20 row_ror:8 row_mask:0xf bank_mask:0xf
    v_add_f32_dpp v24, v24, v24 row_ror:8 row_mask:0xf bank_mask:0xf
    v_mov_b32 v25, v24
    s_nop 1
    v_permlane16_swap_b32 v24, v25
    v_mul_f32 v24, 0.001953125, v24
    v_mul_f32 v25, 0.001953125, v25
    v_fma_f32 v16, -v24, v20, v16
    v_fma_f32 v25, -v24, v24, v25
    v_add_f32 v25, 0x3727c5ac, v25
    v_rsq_f32 v25, v25
    s_nop 0
    v_mul_f32 v16, v16, v25
    s_nop 1
    v_mov_b32_dpp v17, v16 row_half_mirror row_mask:0xf bank_mask:0xf
    v_mul_f32 v18, v16, v16
    v_mov_b32 v19, 0xc0135761
    v_mov_b32_dpp v17, v17 quad_perm:[3,2,1,0] row_mask:0xf bank_mask:0xf
    v_fmac_f32 v19, 0xbdd2d3e8, v18
    v_mul_f32 v19, v19, v16
    v_exp_f32 v19, v19
    v_mul_f32 v17, v17, v16
    v_add_f32 v19, 1.0, v19
    v_rcp_f32 v19, v19
    s_nop 0
    v_mul_f32 v19, v19, v17
    v_cvt_pk_bf16_f32 v19, v19, v19
    s_mov_b32 exec_lo, 0x0f0f0f0f
    s_mov_b32 exec_hi, 0x0f0f0f0f
    ds_write_b16 v57, v19
    s_mov_b64 exec, -1
    s_waitcnt lgkmcnt(0)
    s_barrier
    ds_read_b64_tr_b16 v[52:53], v42 offset:16384
    ds_read_b64_tr_b16 v[54:55], v42 offset:17408
    ds_read_b128 v[32:35], v58
    s_waitcnt lgkmcnt(0)
    v_mfma_f32_16x16x32_bf16 v[64:67], v[52:55], v[32:35], v[64:67]
    s_nop 7
    v_perm_b32 v64, v64, v2, s35
    v_perm_b32 v65, v65, v2, s35
    v_perm_b32 v66, v66, v2, s35
    v_perm_b32 v67, v67, v2, s35
    s_mov_b64 exec, s[70:71]
    global_store_dwordx4 v59, v[64:67], s[26:27] sc1
    s_mov_b64 exec, -1
    s_branch L_fin
L_final:
    s_cmp_ge_u32 s32, 4
    s_cbranch_scc1 L_fin
    s_sub_u32 s41, s29, 28
    s_lshl_b32 s41, s41, 2
    s_add_u32 s41, s41, s32
    s_lshl_b32 s42, s28, 10
    s_lshl_b32 s43, s41, 6
    s_add_u32 s42, s42, s43
    s_add_u32 s42, s42, 65536
    s_lshl_b32 s43, s28, 4
    s_add_u32 s41, s41, s43
    v_lshrrev_b32 v11, 2, v1
    v_and_b32 v12, 3, v1
    v_lshlrev_b32 v13, 13, v11
    v_lshl_add_u32 v13, v12, 4, v13
    v_add_u32 v13, s42, v13
    v_add_u32 v14, 0x20000, v13
    s_lshl_b32 s43, s41, 3
    v_lshlrev_b32 v34, 10, v12
    v_lshl_add_u32 v34, v8, 1, v34
    v_add_u32 v34, s43, v34
    v_add_u32 v15, 147456, v34
    ds_read_u16 v40, v15
    s_lshr_b32 s42, s41, 5
    s_mul_i32 s42, s42, 114688
    s_and_b32 s43, s41, 31
    s_lshl_b32 s43, s43, 6
    s_add_u32 s42, s42, s43
    s_add_u32 s42, s42, 2097152
    v_lshlrev_b32 v35, 11, v11
    v_lshl_add_u32 v35, v12, 4, v35
    v_add_u32 v35, s42, v35
    v_add_u32 v36, 0x8000, v35
    v_add_u32 v37, 0x10000, v35
    v_add_u32 v32, 0x18000, v35
    v_cmp_gt_u32 s[60:61], 32, v1
    s_nop 1
    v_cndmask_b32 v32, v35, v32, s[60:61]
    v_cndmask_b32 v33, 0, 1.0, s[60:61]
    s_sleep 20
L_gh_19:
    global_load_dwordx4 v[16:19], v13, s[26:27] sc1
    global_load_dwordx4 v[20:23], v14, s[26:27] sc1
    s_waitcnt vmcnt(0)
    v_xor_b32 v3, v16, v2
    v_bitop3_b32 v3, v3, v17, v2 bitop3:0xF6
    v_bitop3_b32 v3, v3, v18, v2 bitop3:0xF6
    v_bitop3_b32 v3, v3, v19, v2 bitop3:0xF6
    v_bitop3_b32 v3, v3, v20, v2 bitop3:0xF6
    v_bitop3_b32 v3, v3, v21, v2 bitop3:0xF6
    v_bitop3_b32 v3, v3, v22, v2 bitop3:0xF6
    v_bitop3_b32 v3, v3, v23, v2 bitop3:0xF6
    v_and_b32 v3, 0xff, v3
    v_cmp_ne_u32 vcc, 0, v3
    s_cbranch_vccz L_gh_19_ok
    s_sleep 8
    s_add_u32 s66, s66, 1
    s_cmp_lt_u32 s66, 30000
    s_cbranch_scc1 L_gh_19
L_gh_19_ok:
    v_add_f32 v44, v16, v20
    v_add_f32 v45, v17, v21
    v_add_f32 v46, v18, v22
    v_add_f32 v47, v19, v23
    s_sleep 40
L_gd_20:
    global_load_dwordx4 v[16:19], v35, s[26:27] sc1
    global_load_dwordx4 v[20:23], v36, s[26:27] sc1
    global_load_dwordx4 v[24:27], v37, s[26:27] sc1
    global_load_dwordx4 v[28:31], v32, s[26:27] sc1
    s_waitcnt vmcnt(0)
    v_xor_b32 v3, v16, v2
    v_bitop3_b32 v3, v3, v17, v2 bitop3:0xF6
    v_bitop3_b32 v3, v3, v18, v2 bitop3:0xF6
    v_bitop3_b32 v3, v3, v19, v2 bitop3:0xF6
    v_bitop3_b32 v3, v3, v20, v2 bitop3:0xF6
    v_bitop3_b32 v3, v3, v21, v2 bitop3:0xF6
    v_bitop3_b32 v3, v3, v22, v2 bitop3:0xF6
    v_bitop3_b32 v3, v3, v23, v2 bitop3:0xF6
    v_bitop3_b32 v3, v3, v24, v2 bitop3:0xF6
    v_bitop3_b32 v3, v3, v25, v2 bitop3:0xF6
    v_bitop3_b32 v3, v3, v26, v2 bitop3:0xF6
    v_bitop3_b32 v3, v3, v27, v2 bitop3:0xF6
    v_bitop3_b32 v3, v3, v28, v2 bitop3:0xF6
    v_bitop3_b32 v3, v3, v29, v2 bitop3:0xF6
    v_bitop3_b32 v3, v3, v30, v2 bitop3:0xF6
    v_bitop3_b32 v3, v3, v31, v2 bitop3:0xF6
    v_and_b32 v3, 0xff, v3
    v_cmp_ne_u32 vcc, 0, v3
    s_cbranch_vccz L_gd_20_ok
    s_sleep 4
    s_add_u32 s66, s66, 1
    s_cmp_lt_u32 s66, 30000
    s_cbranch_scc1 L_gd_20
L_gd_20_ok:
    v_add_f32 v44, v44, v16
    v_add_f32 v45, v45, v17
    v_add_f32 v46, v46, v18
    v_add_f32 v47, v47, v19
    v_add_f32 v20, v20, v24
    v_add_f32 v21, v21, v25
    v_add_f32 v22, v22, v26
    v_add_f32 v23, v23, v27
    v_fmac_f32 v44, v33, v28
    v_fmac_f32 v45, v33, v29
    v_fmac_f32 v46, v33, v30
    v_fmac_f32 v47, v33, v31
    v_add_f32 v44, v44, v20
    v_add_f32 v45, v45, v21
    v_add_f32 v46, v46, v22
    v_add_f32 v47, v47, v23
    v_permlane16_swap_b32 v44, v45
    s_nop 0
    v_permlane16_swap_b32 v46, v47
    v_add_f32 v44, v44, v45
    v_add_f32 v46, v46, v47
    s_nop 1
    v_permlane32_swap_b32 v44, v46
    v_add_f32 v44, v44, v46
    s_waitcnt lgkmcnt(0)
    v_lshlrev_b32 v40, 16, v40
    v_add_f32_dpp v44, v44, v44 row_ror:4 row_mask:0xf bank_mask:0xf
    s_nop 1
    v_add_f32_dpp v44, v44, v44 row_ror:8 row_mask:0xf bank_mask:0xf
    v_add_f32 v44, v44, v40
    v_cvt_pk_bf16_f32 v44, v44, v44
    s_mov_b32 exec_lo, 0x000f000f
    s_mov_b32 exec_hi, 0x000f000f
    global_store_short v34, v44, s[22:23]
    s_mov_b64 exec, -1
    s_cmp_eq_u32 s41, 0
    s_cbranch_scc0 L_fin
    v_mov_b32 v16, 0
    v_mov_b32 v17, s34
    s_mov_b64 exec, 1
    global_store_dword v16, v17, s[26:27] sc1
    s_mov_b64 exec, -1
L_fin:
L_end:
    s_endpgm

.section .rodata,"a"
.p2align 6
.amdhsa_kernel sequential_preLN__sliding_block_cached__geglu_ffn__decode_kernel
  .amdhsa_next_free_vgpr 252
  .amdhsa_next_free_sgpr 102
  .amdhsa_accum_offset 252
  .amdhsa_group_segment_fixed_size 0
  .amdhsa_kernarg_size 96
  .amdhsa_user_sgpr_count 2
  .amdhsa_user_sgpr_kernarg_segment_ptr 1
  .amdhsa_system_sgpr_workgroup_id_x 1
.end_amdhsa_kernel
```
